```python
import torch

def _softmax(x, axis=-1):
    return torch.softmax(x, dim=axis)
def _gelu(x):
    return torch.nn.functional.gelu(x, approximate="tanh")
def _silu(x):
    return torch.nn.functional.silu(x)
def _sigmoid(x):
    return torch.sigmoid(x)
def _layernorm(x, axis=-1, eps=1e-5):
    m = x.mean(dim=axis, keepdim=True)
    v = x.var(dim=axis, keepdim=True, unbiased=False)
    return (x - m) / torch.sqrt(v + eps)
def _scatter_add(tgt, idx, src, axis=0):
    return tgt.clone().index_add_(axis, idx, src)
def _segment_sum(src, seg, n):
    out = torch.zeros((n,) + src.shape[1:], dtype=src.dtype)
    return out.index_add_(0, seg, src)
def _pad(x, pw):
    flat = tuple(v for pair in reversed(pw) for v in pair)
    return torch.nn.functional.pad(x, flat)

kernel_name = 'parallel_sum__mha_block_cached__glu_gated_bilinear__decode'

def setup_inputs():

    _w = (lambda a: (lambda t: t.to(torch.bfloat16) if t.is_floating_point() else t)(torch.as_tensor(a)))
    def _A_setup():
        B, Sq, D = 4, 1, 640
        H, Sk, Dh = 32, 4096, 128
        return {
            "x": _w((lambda *s: torch.randn(*s, dtype=torch.bfloat16) * 0.05)(B, Sq, D)),
            "k_cache": _w((lambda *s: torch.randn(*s, dtype=torch.bfloat16) * 1.6)(B, H, Sk, Dh)),
            "v_cache": _w((lambda *s: torch.randn(*s, dtype=torch.bfloat16) * 0.8)(B, H, Sk, Dh)),
            "wq": _w((lambda *s: torch.randn(*s, dtype=torch.bfloat16) * 1.6)(D, H * Dh) * (D ** -0.5)),
            "wo": _w((lambda *s: torch.randn(*s, dtype=torch.bfloat16) * 0.8)(H * Dh, D) * ((H * Dh) ** -0.5)),
        }
    _A_in = _A_setup()

    def _B_setup():
        B, S, D, F = 4, 1, 640, 1728
        return {
            "x": _w((lambda *s: torch.randn(*s, dtype=torch.bfloat16) * 0.05)(B, S, D)),
            "w_gate": _w((lambda *s: torch.randn(*s, dtype=torch.bfloat16) * 0.4)(D, F) * (D ** -0.5)),
            "w_up": _w((lambda *s: torch.randn(*s, dtype=torch.bfloat16) * 0.4)(D, F) * (D ** -0.5)),
            "w_down": _w((lambda *s: torch.randn(*s, dtype=torch.bfloat16) * 0.4)(F, D) * (F ** -0.5)),
        }
    _B_in = _B_setup()

    return {
        "A_x": _A_in["x"],
        "A_k_cache": _A_in["k_cache"],
        "A_v_cache": _A_in["v_cache"],
        "A_wq": _A_in["wq"],
        "A_wo": _A_in["wo"],
        "B_x": _B_in["x"],
        "B_w_gate": _B_in["w_gate"],
        "B_w_up": _B_in["w_up"],
        "B_w_down": _B_in["w_down"],
    }

def reference(A_x, A_k_cache, A_v_cache, A_wq, A_wo, B_x, B_w_gate, B_w_up, B_w_down):
    def _A_ref(x, k_cache, v_cache, wq, wo):
        B, Sq, D = x.shape
        H, Dh = 32, 128
        q = (lambda x, *d: x.permute(*d))((x @ wq).reshape(B, Sq, H, Dh), 0, 2, 1, 3)
        scores = torch.einsum("bhqd,bhkd->bhqk", q, k_cache) * (Dh ** -0.5)
        p = _softmax(scores, axis=-1)
        o = torch.einsum("bhqk,bhkd->bhqd", p, v_cache)
        return (lambda x, *d: x.permute(*d))(o, 0, 2, 1, 3).reshape(B, Sq, H * Dh) @ wo

    def _B_ref(x, w_gate, w_up, w_down):
        g = torch.einsum("bsd,df->bsf", x, w_gate)
        u = torch.einsum("bsd,df->bsf", x, w_up)
        h = g * u
        return torch.einsum("bsf,fd->bsd", h, w_down)

    x = A_x
    xn = _layernorm(x, axis=-1)
    return x + _A_ref(xn, A_k_cache, A_v_cache, A_wq, A_wo) + _B_ref(xn, B_w_gate, B_w_up, B_w_down)
```

```asm
; @launch grid=(256,1,1) block=(512,1,1) lds=16896
.amdgcn_target "amdgcn-amd-amdhsa--gfx950"
.text
.globl parallel_sum__mha_block_cached__glu_gated_bilinear__decode_kernel
.p2align 8
.type parallel_sum__mha_block_cached__glu_gated_bilinear__decode_kernel,@function
parallel_sum__mha_block_cached__glu_gated_bilinear__decode_kernel:
    s_cmp_ge_u32 s2, 256
    s_cbranch_scc1 L_END
    s_load_dwordx16 s[52:67], s[0:1], 0
    s_load_dwordx8 s[68:75], s[0:1], 64
    v_lshrrev_b32 v20, 6, v0
    v_and_b32 v1, 63, v0
    v_readfirstlane_b32 s76, v20
    s_and_b32 s82, s2, 7
    s_lshr_b32 s83, s2, 3
    s_and_b32 s92, s83, 3
    s_lshl_b32 s78, s82, 2
    s_add_u32 s78, s78, s92
    s_lshr_b32 s8, s83, 2
    s_lshr_b32 s77, s8, 1
    s_and_b32 s79, s8, 1
    s_lshl_b32 s80, s78, 1
    s_add_u32 s80, s80, s79
    s_lshl_b32 s81, s92, 4
    s_lshl_b32 s82, s82, 1
    s_add_u32 s81, s81, s82
    s_add_u32 s81, s81, s79
    s_mov_b32 s87, 0xffff0000
    s_mul_i32 s97, s77, 1280
    s_cmp_ge_u32 s76, 4
    s_cbranch_scc1 L_SWAVE
    s_lshl_b32 s83, s78, 8
    v_bfe_u32 v21, v0, 4, 2
    v_and_b32 v22, 15, v0
    v_mul_u32_u24 v23, 160, v20
    v_add_u32 v24, v23, v21
    v_lshlrev_b32 v26, 13, v24
    v_lshl_add_u32 v26, v22, 4, v26
    s_mul_i32 s82, s8, 5
    v_add_u32 v49, s82, v22
    v_subrev_u32 v25, 40, v49
    v_min_u32 v49, v49, v25
    v_lshl_add_u32 v49, v49, 2, v24
    v_lshlrev_b32 v49, 1, v49
    v_add_u32 v50, s82, v22
    v_add_u32 v50, 16, v50
    v_subrev_u32 v25, 40, v50
    v_min_u32 v50, v50, v25
    v_lshl_add_u32 v50, v50, 2, v24
    v_lshlrev_b32 v50, 1, v50
    v_add_u32 v51, s82, v22
    v_add_u32 v51, 32, v51
    v_subrev_u32 v25, 40, v51
    v_min_u32 v51, v51, v25
    v_lshl_add_u32 v51, v51, 2, v24
    v_lshlrev_b32 v51, 1, v51
    v_lshrrev_b32 v44, 2, v1
    v_add_u32 v44, v44, v23
    v_lshlrev_b32 v61, 1, v44
    v_lshlrev_b32 v28, 4, v1
    v_lshlrev_b32 v32, 2, v1
    s_lshl_b32 s84, s82, 15
    s_waitcnt lgkmcnt(0)
    s_add_u32 s36, s52, s97
    s_addc_u32 s37, s53, 0
    s_mov_b32 s38, 0x500
    s_mov_b32 s39, 0x20000
    s_add_u32 s16, s58, s83
    s_addc_u32 s17, s59, 0
    s_mov_b32 s18, 0x4fe100
    s_mov_b32 s19, 0x20000
    buffer_load_dword v32, v32, s[36:39], 0 offen offset:1024
    buffer_load_dwordx4 v[28:31], v28, s[36:39], 0 offen
    buffer_load_ushort v49, v49, s[36:39], 0 offen
    buffer_load_ushort v50, v50, s[36:39], 0 offen
    buffer_load_ushort v51, v51, s[36:39], 0 offen
    buffer_load_dwordx4 v[64:67], v26, s[16:19], s84 offen
    s_add_u32 s84, s84, 32768
    s_cmp_eq_u32 s84, 1310720
    s_cselect_b32 s84, 0, s84
    buffer_load_dwordx4 v[68:71], v26, s[16:19], s84 offen
    s_add_u32 s84, s84, 32768
    s_cmp_eq_u32 s84, 1310720
    s_cselect_b32 s84, 0, s84
    buffer_load_dwordx4 v[72:75], v26, s[16:19], s84 offen
    s_add_u32 s84, s84, 32768
    s_cmp_eq_u32 s84, 1310720
    s_cselect_b32 s84, 0, s84
    buffer_load_dwordx4 v[76:79], v26, s[16:19], s84 offen
    s_add_u32 s84, s84, 32768
    s_cmp_eq_u32 s84, 1310720
    s_cselect_b32 s84, 0, s84
    buffer_load_dwordx4 v[80:83], v26, s[16:19], s84 offen
    s_add_u32 s84, s84, 32768
    s_cmp_eq_u32 s84, 1310720
    s_cselect_b32 s84, 0, s84
    s_mul_i32 s82, s77, 96
    buffer_load_ushort v52, v61, s[36:39], s82 offen
    s_add_u32 s82, s82, 32
    s_cmp_eq_u32 s82, 320
    s_cselect_b32 s82, 0, s82
    buffer_load_ushort v53, v61, s[36:39], s82 offen
    s_add_u32 s82, s82, 32
    s_cmp_eq_u32 s82, 320
    s_cselect_b32 s82, 0, s82
    buffer_load_ushort v54, v61, s[36:39], s82 offen
    s_add_u32 s82, s82, 32
    s_cmp_eq_u32 s82, 320
    s_cselect_b32 s82, 0, s82
    buffer_load_ushort v55, v61, s[36:39], s82 offen
    s_add_u32 s82, s82, 32
    s_cmp_eq_u32 s82, 320
    s_cselect_b32 s82, 0, s82
    buffer_load_ushort v56, v61, s[36:39], s82 offen
    s_add_u32 s82, s82, 32
    s_cmp_eq_u32 s82, 320
    s_cselect_b32 s82, 0, s82
    buffer_load_ushort v57, v61, s[36:39], s82 offen
    s_add_u32 s82, s82, 32
    s_cmp_eq_u32 s82, 320
    s_cselect_b32 s82, 0, s82
    buffer_load_ushort v58, v61, s[36:39], s82 offen
    s_add_u32 s82, s82, 32
    s_cmp_eq_u32 s82, 320
    s_cselect_b32 s82, 0, s82
    buffer_load_ushort v59, v61, s[36:39], s82 offen
    s_add_u32 s82, s82, 32
    s_cmp_eq_u32 s82, 320
    s_cselect_b32 s82, 0, s82
    buffer_load_ushort v60, v61, s[36:39], s82 offen
    s_add_u32 s82, s82, 32
    s_cmp_eq_u32 s82, 320
    s_cselect_b32 s82, 0, s82
    buffer_load_ushort v61, v61, s[36:39], s82 offen
    s_mul_i32 s82, s78, 163840
    s_add_u32 s20, s60, s82
    s_addc_u32 s21, s61, 0
    s_mov_b32 s22, 0x28000
    s_mov_b32 s23, 0x20000
    s_lshl_b32 s82, s81, 6
    s_add_u32 s24, s64, s82
    s_addc_u32 s25, s65, 0
    s_mov_b32 s26, 0x21b2c0
    s_mov_b32 s27, 0x20000
    s_add_u32 s28, s66, s82
    s_addc_u32 s29, s67, 0
    s_mov_b32 s30, 0x21b2c0
    s_mov_b32 s31, 0x20000
    s_mul_i32 s82, s81, 40960
    s_add_u32 s32, s68, s82
    s_addc_u32 s33, s69, 0
    s_mov_b32 s34, 0xa000
    s_mov_b32 s35, 0x20000
    s_add_u32 s40, s70, s97
    s_addc_u32 s41, s71, 0
    s_mov_b32 s42, 0x500
    s_mov_b32 s43, 0x20000
    s_mov_b32 s48, s72
    s_mov_b32 s49, s73
    s_mov_b32 s50, 0x100
    s_mov_b32 s51, 0x20000
    s_mov_b32 s44, s74
    s_mov_b32 s45, s75
    s_mov_b32 s46, 0x141000
    s_mov_b32 s47, 0x20000
    v_mul_u32_u24 v44, 3456, v44
    v_and_b32 v25, 3, v0
    v_lshl_add_u32 v44, v25, 4, v44
    v_lshl_add_u32 v27, v20, 5, v21
    v_mul_u32_u24 v27, 1280, v27
    v_lshl_add_u32 v27, v22, 4, v27
    v_mul_u32_u24 v45, 1280, v21
    v_lshl_add_u32 v45, v22, 4, v45
    v_lshl_add_u32 v45, v20, 8, v45
    v_and_b32 v23, 1, v0
    v_lshlrev_b32 v23, 4, v23
    v_mov_b32 v24, 0xffff
    v_lshlrev_b32 v23, v23, v24
    v_bfe_u32 v24, v0, 1, 3
    v_cmp_eq_u32 vcc, 0, v24
    s_nop 1
    v_cndmask_b32 v4, 0, v23, vcc
    v_cmp_eq_u32 vcc, 1, v24
    s_nop 1
    v_cndmask_b32 v5, 0, v23, vcc
    v_cmp_eq_u32 vcc, 2, v24
    s_nop 1
    v_cndmask_b32 v6, 0, v23, vcc
    v_cmp_eq_u32 vcc, 3, v24
    s_nop 1
    v_cndmask_b32 v7, 0, v23, vcc
    s_lshl_b32 s82, s77, 6
    s_add_u32 s96, s82, s81
    s_mul_i32 s96, s96, 2560
    s_add_u32 s96, s96, 655360
    s_add_u32 s82, s82, s80
    s_mul_i32 s83, s82, 2560
    s_lshl_b32 s82, s82, 3
    s_add_u32 s82, s82, 1310720
    v_and_b32 v22, 0xff, v0
    v_lshlrev_b32 v24, 4, v22
    v_cmp_gt_u32 vcc, 160, v22
    v_mov_b32 v25, 0x7ffffff0
    s_nop 0
    v_cndmask_b32 v62, v25, v24, vcc
    v_add_u32 v24, s83, v24
    v_cndmask_b32 v2, v25, v24, vcc
    v_cmp_eq_u32 vcc, 192, v0
    v_mov_b32 v24, s82
    s_nop 0
    v_cndmask_b32 v252, v25, v24, vcc
    v_and_b32 v23, 15, v0
    v_bfe_u32 v24, v0, 4, 2
    v_bfe_u32 v25, v0, 6, 2
    v_lshlrev_b32 v3, 5, v23
    v_lshl_add_u32 v3, v24, 4, v3
    v_lshl_add_u32 v3, v25, 9, v3
    v_mov_b32 v12, -1
    v_mov_b32 v13, -1
    v_mov_b32 v14, -1
    v_mov_b32 v15, -1
    buffer_store_dwordx4 v[12:15], v2, s[44:47], 0 offen sc1
    buffer_store_dwordx4 v[12:15], v62, s[44:47], s96 offen sc1
    buffer_store_dwordx2 v[12:13], v252, s[44:47], 0 offen sc1
    v_mov_b32 v8, 0
    v_mov_b32 v9, 0
    v_mov_b32 v10, 0
    v_mov_b32 v11, 0
    ds_write_b128 v8, v[8:11] offset:4128
    ds_write_b128 v8, v[8:11] offset:4144
    s_waitcnt vmcnt(18)
    v_lshlrev_b32 v33, 16, v28
    v_and_b32 v34, s87, v28
    v_lshlrev_b32 v35, 16, v29
    v_and_b32 v36, s87, v29
    v_lshlrev_b32 v37, 16, v30
    v_and_b32 v38, s87, v30
    v_lshlrev_b32 v39, 16, v31
    v_and_b32 v40, s87, v31
    v_lshlrev_b32 v41, 16, v32
    v_and_b32 v42, s87, v32
    v_add_f32 v20, v33, v34
    v_add_f32 v21, v35, v36
    v_add_f32 v22, v37, v38
    v_add_f32 v23, v39, v40
    v_add_f32 v24, v41, v42
    v_add_f32 v20, v20, v21
    v_add_f32 v22, v22, v23
    v_add_f32 v20, v20, v24
    v_add_f32 v20, v20, v22
    s_nop 1
    v_add_f32_dpp v20, v20, v20 quad_perm:[1,0,3,2] row_mask:0xf bank_mask:0xf
    s_nop 1
    v_add_f32_dpp v20, v20, v20 quad_perm:[2,3,0,1] row_mask:0xf bank_mask:0xf
    s_nop 1
    v_add_f32_dpp v20, v20, v20 row_half_mirror row_mask:0xf bank_mask:0xf
    s_nop 1
    v_add_f32_dpp v20, v20, v20 row_mirror row_mask:0xf bank_mask:0xf
    v_mov_b32 v21, v20
    s_nop 1
    v_permlane16_swap_b32 v21, v20
    v_add_f32 v20, v20, v21
    v_mov_b32 v21, v20
    s_nop 1
    v_permlane32_swap_b32 v21, v20
    v_add_f32 v20, v20, v21
    v_mul_f32 v20, 0x3acccccd, v20
    v_sub_f32 v33, v33, v20
    v_sub_f32 v34, v34, v20
    v_sub_f32 v35, v35, v20
    v_sub_f32 v36, v36, v20
    v_sub_f32 v37, v37, v20
    v_sub_f32 v38, v38, v20
    v_sub_f32 v39, v39, v20
    v_sub_f32 v40, v40, v20
    v_sub_f32 v41, v41, v20
    v_sub_f32 v42, v42, v20
    v_mul_f32 v22, v33, v33
    v_mul_f32 v23, v34, v34
    v_fmac_f32 v22, v35, v35
    v_fmac_f32 v23, v36, v36
    v_fmac_f32 v22, v37, v37
    v_fmac_f32 v23, v38, v38
    v_fmac_f32 v22, v39, v39
    v_fmac_f32 v23, v40, v40
    v_fmac_f32 v22, v41, v41
    v_fmac_f32 v23, v42, v42
    v_add_f32 v22, v22, v23
    s_nop 1
    v_add_f32_dpp v22, v22, v22 quad_perm:[1,0,3,2] row_mask:0xf bank_mask:0xf
    s_nop 1
    v_add_f32_dpp v22, v22, v22 quad_perm:[2,3,0,1] row_mask:0xf bank_mask:0xf
    s_nop 1
    v_add_f32_dpp v22, v22, v22 row_half_mirror row_mask:0xf bank_mask:0xf
    s_nop 1
    v_add_f32_dpp v22, v22, v22 row_mirror row_mask:0xf bank_mask:0xf
    v_mov_b32 v21, v22
    s_nop 1
    v_permlane16_swap_b32 v21, v22
    v_add_f32 v22, v22, v21
    v_mov_b32 v21, v22
    s_nop 1
    v_permlane32_swap_b32 v21, v22
    v_add_f32 v22, v22, v21
    v_mul_f32 v22, 0x3acccccd, v22
    v_cvt_pk_bf16_f32 v21, v20, v22
    v_lshlrev_b32 v46, 16, v21
    v_and_b32 v21, s87, v21
    v_add_f32 v21, 0x3727c5ac, v21
    v_cvt_pk_bf16_f32 v21, v21, v21
    v_and_b32 v21, s87, v21
    v_sqrt_f32 v22, v21
    s_nop 0
    v_rcp_f32 v23, v22
    v_fma_f32 v24, -v22, v22, v21
    v_mul_f32 v23, 0.5, v23
    v_fmac_f32 v22, v24, v23
    v_cvt_pk_bf16_f32 v22, v22, v22
    v_and_b32 v47, s87, v22
    v_rcp_f32 v48, v47
    v_lshlrev_b32 v49, 16, v49
    v_sub_f32 v49, v49, v46
    v_cvt_pk_bf16_f32 v49, v49, v49
    v_and_b32 v49, s87, v49
    v_mul_f32 v20, v49, v48
    v_fma_f32 v21, -v20, v47, v49
    v_fmac_f32 v20, v21, v48
    v_cvt_pk_bf16_f32 v49, v20, v20
    v_lshlrev_b32 v50, 16, v50
    v_sub_f32 v50, v50, v46
    v_cvt_pk_bf16_f32 v50, v50, v50
    v_and_b32 v50, s87, v50
    v_mul_f32 v22, v50, v48
    v_fma_f32 v23, -v22, v47, v50
    v_fmac_f32 v22, v23, v48
    v_cvt_pk_bf16_f32 v50, v22, v22
    v_lshlrev_b32 v51, 16, v51
    v_sub_f32 v51, v51, v46
    v_cvt_pk_bf16_f32 v51, v51, v51
    v_and_b32 v51, s87, v51
    v_mul_f32 v24, v51, v48
    v_fma_f32 v25, -v24, v47, v51
    v_fmac_f32 v24, v25, v48
    v_cvt_pk_bf16_f32 v51, v24, v24
    s_waitcnt vmcnt(13)
    buffer_load_dwordx4 v[84:87], v26, s[16:19], s84 offen
    s_add_u32 s84, s84, 32768
    s_cmp_eq_u32 s84, 1310720
    s_cselect_b32 s84, 0, s84
    buffer_load_dwordx4 v[88:91], v26, s[16:19], s84 offen
    s_add_u32 s84, s84, 32768
    s_cmp_eq_u32 s84, 1310720
    s_cselect_b32 s84, 0, s84
    buffer_load_dwordx4 v[92:95], v26, s[16:19], s84 offen
    s_add_u32 s84, s84, 32768
    s_cmp_eq_u32 s84, 1310720
    s_cselect_b32 s84, 0, s84
    buffer_load_dwordx4 v[96:99], v26, s[16:19], s84 offen
    s_add_u32 s84, s84, 32768
    s_cmp_eq_u32 s84, 1310720
    s_cselect_b32 s84, 0, s84
    buffer_load_dwordx4 v[100:103], v26, s[16:19], s84 offen
    s_add_u32 s84, s84, 32768
    s_cmp_eq_u32 s84, 1310720
    s_cselect_b32 s84, 0, s84
    buffer_load_dwordx4 v[104:107], v26, s[16:19], s84 offen
    s_add_u32 s84, s84, 32768
    s_cmp_eq_u32 s84, 1310720
    s_cselect_b32 s84, 0, s84
    buffer_load_dwordx4 v[108:111], v26, s[16:19], s84 offen
    s_add_u32 s84, s84, 32768
    s_cmp_eq_u32 s84, 1310720
    s_cselect_b32 s84, 0, s84
    buffer_load_dwordx4 v[112:115], v26, s[16:19], s84 offen
    s_add_u32 s84, s84, 32768
    s_cmp_eq_u32 s84, 1310720
    s_cselect_b32 s84, 0, s84
    buffer_load_dwordx4 v[116:119], v26, s[16:19], s84 offen
    s_add_u32 s84, s84, 32768
    s_cmp_eq_u32 s84, 1310720
    s_cselect_b32 s84, 0, s84
    buffer_load_dwordx4 v[120:123], v26, s[16:19], s84 offen
    s_add_u32 s84, s84, 32768
    s_cmp_eq_u32 s84, 1310720
    s_cselect_b32 s84, 0, s84
    buffer_load_dwordx4 v[124:127], v26, s[16:19], s84 offen
    s_add_u32 s84, s84, 32768
    s_cmp_eq_u32 s84, 1310720
    s_cselect_b32 s84, 0, s84
    buffer_load_dwordx4 v[128:131], v26, s[16:19], s84 offen
    s_add_u32 s84, s84, 32768
    s_cmp_eq_u32 s84, 1310720
    s_cselect_b32 s84, 0, s84
    buffer_load_dwordx4 v[132:135], v26, s[16:19], s84 offen
    s_add_u32 s84, s84, 32768
    s_cmp_eq_u32 s84, 1310720
    s_cselect_b32 s84, 0, s84
    buffer_load_dwordx4 v[136:139], v26, s[16:19], s84 offen
    s_add_u32 s84, s84, 32768
    s_cmp_eq_u32 s84, 1310720
    s_cselect_b32 s84, 0, s84
    buffer_load_dwordx4 v[140:143], v26, s[16:19], s84 offen
    s_add_u32 s84, s84, 32768
    s_cmp_eq_u32 s84, 1310720
    s_cselect_b32 s84, 0, s84
    buffer_load_dwordx4 v[144:147], v26, s[16:19], s84 offen
    s_add_u32 s84, s84, 32768
    s_cmp_eq_u32 s84, 1310720
    s_cselect_b32 s84, 0, s84
    buffer_load_dwordx4 v[148:151], v26, s[16:19], s84 offen
    s_add_u32 s84, s84, 32768
    s_cmp_eq_u32 s84, 1310720
    s_cselect_b32 s84, 0, s84
    buffer_load_dwordx4 v[152:155], v26, s[16:19], s84 offen
    s_add_u32 s84, s84, 32768
    s_cmp_eq_u32 s84, 1310720
    s_cselect_b32 s84, 0, s84
    buffer_load_dwordx4 v[156:159], v26, s[16:19], s84 offen
    s_add_u32 s84, s84, 32768
    s_cmp_eq_u32 s84, 1310720
    s_cselect_b32 s84, 0, s84
    buffer_load_dwordx4 v[160:163], v26, s[16:19], s84 offen
    s_add_u32 s84, s84, 32768
    s_cmp_eq_u32 s84, 1310720
    s_cselect_b32 s84, 0, s84
    buffer_load_dwordx4 v[164:167], v26, s[16:19], s84 offen
    s_add_u32 s84, s84, 32768
    s_cmp_eq_u32 s84, 1310720
    s_cselect_b32 s84, 0, s84
    buffer_load_dwordx4 v[168:171], v26, s[16:19], s84 offen
    s_add_u32 s84, s84, 32768
    s_cmp_eq_u32 s84, 1310720
    s_cselect_b32 s84, 0, s84
    buffer_load_dwordx4 v[172:175], v26, s[16:19], s84 offen
    s_add_u32 s84, s84, 32768
    s_cmp_eq_u32 s84, 1310720
    s_cselect_b32 s84, 0, s84
    buffer_load_dwordx4 v[176:179], v26, s[16:19], s84 offen
    s_add_u32 s84, s84, 32768
    s_cmp_eq_u32 s84, 1310720
    s_cselect_b32 s84, 0, s84
    buffer_load_dwordx4 v[180:183], v26, s[16:19], s84 offen
    s_add_u32 s84, s84, 32768
    s_cmp_eq_u32 s84, 1310720
    s_cselect_b32 s84, 0, s84
    buffer_load_dwordx4 v[184:187], v26, s[16:19], s84 offen
    s_add_u32 s84, s84, 32768
    s_cmp_eq_u32 s84, 1310720
    s_cselect_b32 s84, 0, s84
    buffer_load_dwordx4 v[188:191], v26, s[16:19], s84 offen
    s_add_u32 s84, s84, 32768
    s_cmp_eq_u32 s84, 1310720
    s_cselect_b32 s84, 0, s84
    buffer_load_dwordx4 v[192:195], v26, s[16:19], s84 offen
    s_add_u32 s84, s84, 32768
    s_cmp_eq_u32 s84, 1310720
    s_cselect_b32 s84, 0, s84
    buffer_load_dwordx4 v[196:199], v26, s[16:19], s84 offen
    s_add_u32 s84, s84, 32768
    s_cmp_eq_u32 s84, 1310720
    s_cselect_b32 s84, 0, s84
    buffer_load_dwordx4 v[200:203], v26, s[16:19], s84 offen
    s_add_u32 s84, s84, 32768
    s_cmp_eq_u32 s84, 1310720
    s_cselect_b32 s84, 0, s84
    buffer_load_dwordx4 v[204:207], v26, s[16:19], s84 offen
    s_add_u32 s84, s84, 32768
    s_cmp_eq_u32 s84, 1310720
    s_cselect_b32 s84, 0, s84
    buffer_load_dwordx4 v[208:211], v26, s[16:19], s84 offen
    s_add_u32 s84, s84, 32768
    s_cmp_eq_u32 s84, 1310720
    s_cselect_b32 s84, 0, s84
    buffer_load_dwordx4 v[212:215], v26, s[16:19], s84 offen
    s_add_u32 s84, s84, 32768
    s_cmp_eq_u32 s84, 1310720
    s_cselect_b32 s84, 0, s84
    buffer_load_dwordx4 v[216:219], v26, s[16:19], s84 offen
    s_add_u32 s84, s84, 32768
    s_cmp_eq_u32 s84, 1310720
    s_cselect_b32 s84, 0, s84
    buffer_load_dwordx4 v[220:223], v26, s[16:19], s84 offen
    s_barrier
    v_and_b32_dpp v8, v49, v4 row_newbcast:0 row_mask:0xf bank_mask:0xf
    v_and_b32_dpp v9, v49, v5 row_newbcast:0 row_mask:0xf bank_mask:0xf
    v_and_b32_dpp v10, v49, v6 row_newbcast:0 row_mask:0xf bank_mask:0xf
    v_and_b32_dpp v11, v49, v7 row_newbcast:0 row_mask:0xf bank_mask:0xf
    v_and_b32_dpp v12, v49, v4 row_newbcast:1 row_mask:0xf bank_mask:0xf
    v_and_b32_dpp v13, v49, v5 row_newbcast:1 row_mask:0xf bank_mask:0xf
    v_and_b32_dpp v14, v49, v6 row_newbcast:1 row_mask:0xf bank_mask:0xf
    v_and_b32_dpp v15, v49, v7 row_newbcast:1 row_mask:0xf bank_mask:0xf
    v_mfma_f32_16x16x32_bf16 v[16:19], v[8:11], v[64:67], 0
    v_and_b32_dpp v8, v49, v4 row_newbcast:2 row_mask:0xf bank_mask:0xf
    v_and_b32_dpp v9, v49, v5 row_newbcast:2 row_mask:0xf bank_mask:0xf
    v_and_b32_dpp v10, v49, v6 row_newbcast:2 row_mask:0xf bank_mask:0xf
    v_and_b32_dpp v11, v49, v7 row_newbcast:2 row_mask:0xf bank_mask:0xf
    v_mfma_f32_16x16x32_bf16 v[16:19], v[12:15], v[68:71], v[16:19]
    v_and_b32_dpp v12, v49, v4 row_newbcast:3 row_mask:0xf bank_mask:0xf
    v_and_b32_dpp v13, v49, v5 row_newbcast:3 row_mask:0xf bank_mask:0xf
    v_and_b32_dpp v14, v49, v6 row_newbcast:3 row_mask:0xf bank_mask:0xf
    v_and_b32_dpp v15, v49, v7 row_newbcast:3 row_mask:0xf bank_mask:0xf
    v_mfma_f32_16x16x32_bf16 v[16:19], v[8:11], v[72:75], v[16:19]
    v_and_b32_dpp v8, v49, v4 row_newbcast:4 row_mask:0xf bank_mask:0xf
    v_and_b32_dpp v9, v49, v5 row_newbcast:4 row_mask:0xf bank_mask:0xf
    v_and_b32_dpp v10, v49, v6 row_newbcast:4 row_mask:0xf bank_mask:0xf
    v_and_b32_dpp v11, v49, v7 row_newbcast:4 row_mask:0xf bank_mask:0xf
    v_mfma_f32_16x16x32_bf16 v[16:19], v[12:15], v[76:79], v[16:19]
    v_and_b32_dpp v12, v49, v4 row_newbcast:5 row_mask:0xf bank_mask:0xf
    v_and_b32_dpp v13, v49, v5 row_newbcast:5 row_mask:0xf bank_mask:0xf
    v_and_b32_dpp v14, v49, v6 row_newbcast:5 row_mask:0xf bank_mask:0xf
    v_and_b32_dpp v15, v49, v7 row_newbcast:5 row_mask:0xf bank_mask:0xf
    v_mfma_f32_16x16x32_bf16 v[16:19], v[8:11], v[80:83], v[16:19]
    v_and_b32_dpp v8, v49, v4 row_newbcast:6 row_mask:0xf bank_mask:0xf
    v_and_b32_dpp v9, v49, v5 row_newbcast:6 row_mask:0xf bank_mask:0xf
    v_and_b32_dpp v10, v49, v6 row_newbcast:6 row_mask:0xf bank_mask:0xf
    v_and_b32_dpp v11, v49, v7 row_newbcast:6 row_mask:0xf bank_mask:0xf
    s_waitcnt vmcnt(34)
    v_mfma_f32_16x16x32_bf16 v[16:19], v[12:15], v[84:87], v[16:19]
    v_and_b32_dpp v12, v49, v4 row_newbcast:7 row_mask:0xf bank_mask:0xf
    v_and_b32_dpp v13, v49, v5 row_newbcast:7 row_mask:0xf bank_mask:0xf
    v_and_b32_dpp v14, v49, v6 row_newbcast:7 row_mask:0xf bank_mask:0xf
    v_and_b32_dpp v15, v49, v7 row_newbcast:7 row_mask:0xf bank_mask:0xf
    s_waitcnt vmcnt(33)
    v_mfma_f32_16x16x32_bf16 v[16:19], v[8:11], v[88:91], v[16:19]
    v_and_b32_dpp v8, v49, v4 row_newbcast:8 row_mask:0xf bank_mask:0xf
    v_and_b32_dpp v9, v49, v5 row_newbcast:8 row_mask:0xf bank_mask:0xf
    v_and_b32_dpp v10, v49, v6 row_newbcast:8 row_mask:0xf bank_mask:0xf
    v_and_b32_dpp v11, v49, v7 row_newbcast:8 row_mask:0xf bank_mask:0xf
    s_waitcnt vmcnt(32)
    v_mfma_f32_16x16x32_bf16 v[16:19], v[12:15], v[92:95], v[16:19]
    v_and_b32_dpp v12, v49, v4 row_newbcast:9 row_mask:0xf bank_mask:0xf
    v_and_b32_dpp v13, v49, v5 row_newbcast:9 row_mask:0xf bank_mask:0xf
    v_and_b32_dpp v14, v49, v6 row_newbcast:9 row_mask:0xf bank_mask:0xf
    v_and_b32_dpp v15, v49, v7 row_newbcast:9 row_mask:0xf bank_mask:0xf
    s_waitcnt vmcnt(31)
    v_mfma_f32_16x16x32_bf16 v[16:19], v[8:11], v[96:99], v[16:19]
    v_and_b32_dpp v8, v49, v4 row_newbcast:10 row_mask:0xf bank_mask:0xf
    v_and_b32_dpp v9, v49, v5 row_newbcast:10 row_mask:0xf bank_mask:0xf
    v_and_b32_dpp v10, v49, v6 row_newbcast:10 row_mask:0xf bank_mask:0xf
    v_and_b32_dpp v11, v49, v7 row_newbcast:10 row_mask:0xf bank_mask:0xf
    s_waitcnt vmcnt(30)
    v_mfma_f32_16x16x32_bf16 v[16:19], v[12:15], v[100:103], v[16:19]
    v_and_b32_dpp v12, v49, v4 row_newbcast:11 row_mask:0xf bank_mask:0xf
    v_and_b32_dpp v13, v49, v5 row_newbcast:11 row_mask:0xf bank_mask:0xf
    v_and_b32_dpp v14, v49, v6 row_newbcast:11 row_mask:0xf bank_mask:0xf
    v_and_b32_dpp v15, v49, v7 row_newbcast:11 row_mask:0xf bank_mask:0xf
    s_waitcnt vmcnt(29)
    v_mfma_f32_16x16x32_bf16 v[16:19], v[8:11], v[104:107], v[16:19]
    v_and_b32_dpp v8, v49, v4 row_newbcast:12 row_mask:0xf bank_mask:0xf
    v_and_b32_dpp v9, v49, v5 row_newbcast:12 row_mask:0xf bank_mask:0xf
    v_and_b32_dpp v10, v49, v6 row_newbcast:12 row_mask:0xf bank_mask:0xf
    v_and_b32_dpp v11, v49, v7 row_newbcast:12 row_mask:0xf bank_mask:0xf
    s_waitcnt vmcnt(28)
    v_mfma_f32_16x16x32_bf16 v[16:19], v[12:15], v[108:111], v[16:19]
    v_and_b32_dpp v12, v49, v4 row_newbcast:13 row_mask:0xf bank_mask:0xf
    v_and_b32_dpp v13, v49, v5 row_newbcast:13 row_mask:0xf bank_mask:0xf
    v_and_b32_dpp v14, v49, v6 row_newbcast:13 row_mask:0xf bank_mask:0xf
    v_and_b32_dpp v15, v49, v7 row_newbcast:13 row_mask:0xf bank_mask:0xf
    s_waitcnt vmcnt(27)
    v_mfma_f32_16x16x32_bf16 v[16:19], v[8:11], v[112:115], v[16:19]
    v_and_b32_dpp v8, v49, v4 row_newbcast:14 row_mask:0xf bank_mask:0xf
    v_and_b32_dpp v9, v49, v5 row_newbcast:14 row_mask:0xf bank_mask:0xf
    v_and_b32_dpp v10, v49, v6 row_newbcast:14 row_mask:0xf bank_mask:0xf
    v_and_b32_dpp v11, v49, v7 row_newbcast:14 row_mask:0xf bank_mask:0xf
    s_waitcnt vmcnt(26)
    v_mfma_f32_16x16x32_bf16 v[16:19], v[12:15], v[116:119], v[16:19]
    v_and_b32_dpp v12, v49, v4 row_newbcast:15 row_mask:0xf bank_mask:0xf
    v_and_b32_dpp v13, v49, v5 row_newbcast:15 row_mask:0xf bank_mask:0xf
    v_and_b32_dpp v14, v49, v6 row_newbcast:15 row_mask:0xf bank_mask:0xf
    v_and_b32_dpp v15, v49, v7 row_newbcast:15 row_mask:0xf bank_mask:0xf
    s_waitcnt vmcnt(25)
    v_mfma_f32_16x16x32_bf16 v[16:19], v[8:11], v[120:123], v[16:19]
    v_and_b32_dpp v8, v50, v4 row_newbcast:0 row_mask:0xf bank_mask:0xf
    v_and_b32_dpp v9, v50, v5 row_newbcast:0 row_mask:0xf bank_mask:0xf
    v_and_b32_dpp v10, v50, v6 row_newbcast:0 row_mask:0xf bank_mask:0xf
    v_and_b32_dpp v11, v50, v7 row_newbcast:0 row_mask:0xf bank_mask:0xf
    s_waitcnt vmcnt(24)
    v_mfma_f32_16x16x32_bf16 v[16:19], v[12:15], v[124:127], v[16:19]
    v_and_b32_dpp v12, v50, v4 row_newbcast:1 row_mask:0xf bank_mask:0xf
    v_and_b32_dpp v13, v50, v5 row_newbcast:1 row_mask:0xf bank_mask:0xf
    v_and_b32_dpp v14, v50, v6 row_newbcast:1 row_mask:0xf bank_mask:0xf
    v_and_b32_dpp v15, v50, v7 row_newbcast:1 row_mask:0xf bank_mask:0xf
    s_waitcnt vmcnt(23)
    v_mfma_f32_16x16x32_bf16 v[16:19], v[8:11], v[128:131], v[16:19]
    v_and_b32_dpp v8, v50, v4 row_newbcast:2 row_mask:0xf bank_mask:0xf
    v_and_b32_dpp v9, v50, v5 row_newbcast:2 row_mask:0xf bank_mask:0xf
    v_and_b32_dpp v10, v50, v6 row_newbcast:2 row_mask:0xf bank_mask:0xf
    v_and_b32_dpp v11, v50, v7 row_newbcast:2 row_mask:0xf bank_mask:0xf
    s_waitcnt vmcnt(22)
    v_mfma_f32_16x16x32_bf16 v[16:19], v[12:15], v[132:135], v[16:19]
    v_and_b32_dpp v12, v50, v4 row_newbcast:3 row_mask:0xf bank_mask:0xf
    v_and_b32_dpp v13, v50, v5 row_newbcast:3 row_mask:0xf bank_mask:0xf
    v_and_b32_dpp v14, v50, v6 row_newbcast:3 row_mask:0xf bank_mask:0xf
    v_and_b32_dpp v15, v50, v7 row_newbcast:3 row_mask:0xf bank_mask:0xf
    s_waitcnt vmcnt(21)
    v_mfma_f32_16x16x32_bf16 v[16:19], v[8:11], v[136:139], v[16:19]
    v_and_b32_dpp v8, v50, v4 row_newbcast:4 row_mask:0xf bank_mask:0xf
    v_and_b32_dpp v9, v50, v5 row_newbcast:4 row_mask:0xf bank_mask:0xf
    v_and_b32_dpp v10, v50, v6 row_newbcast:4 row_mask:0xf bank_mask:0xf
    v_and_b32_dpp v11, v50, v7 row_newbcast:4 row_mask:0xf bank_mask:0xf
    s_waitcnt vmcnt(20)
    v_mfma_f32_16x16x32_bf16 v[16:19], v[12:15], v[140:143], v[16:19]
    v_and_b32_dpp v12, v50, v4 row_newbcast:5 row_mask:0xf bank_mask:0xf
    v_and_b32_dpp v13, v50, v5 row_newbcast:5 row_mask:0xf bank_mask:0xf
    v_and_b32_dpp v14, v50, v6 row_newbcast:5 row_mask:0xf bank_mask:0xf
    v_and_b32_dpp v15, v50, v7 row_newbcast:5 row_mask:0xf bank_mask:0xf
    s_waitcnt vmcnt(19)
    v_mfma_f32_16x16x32_bf16 v[16:19], v[8:11], v[144:147], v[16:19]
    v_and_b32_dpp v8, v50, v4 row_newbcast:6 row_mask:0xf bank_mask:0xf
    v_and_b32_dpp v9, v50, v5 row_newbcast:6 row_mask:0xf bank_mask:0xf
    v_and_b32_dpp v10, v50, v6 row_newbcast:6 row_mask:0xf bank_mask:0xf
    v_and_b32_dpp v11, v50, v7 row_newbcast:6 row_mask:0xf bank_mask:0xf
    s_waitcnt vmcnt(18)
    v_mfma_f32_16x16x32_bf16 v[16:19], v[12:15], v[148:151], v[16:19]
    v_and_b32_dpp v12, v50, v4 row_newbcast:7 row_mask:0xf bank_mask:0xf
    v_and_b32_dpp v13, v50, v5 row_newbcast:7 row_mask:0xf bank_mask:0xf
    v_and_b32_dpp v14, v50, v6 row_newbcast:7 row_mask:0xf bank_mask:0xf
    v_and_b32_dpp v15, v50, v7 row_newbcast:7 row_mask:0xf bank_mask:0xf
    s_waitcnt vmcnt(17)
    v_mfma_f32_16x16x32_bf16 v[16:19], v[8:11], v[152:155], v[16:19]
    v_and_b32_dpp v8, v50, v4 row_newbcast:8 row_mask:0xf bank_mask:0xf
    v_and_b32_dpp v9, v50, v5 row_newbcast:8 row_mask:0xf bank_mask:0xf
    v_and_b32_dpp v10, v50, v6 row_newbcast:8 row_mask:0xf bank_mask:0xf
    v_and_b32_dpp v11, v50, v7 row_newbcast:8 row_mask:0xf bank_mask:0xf
    s_waitcnt vmcnt(16)
    v_mfma_f32_16x16x32_bf16 v[16:19], v[12:15], v[156:159], v[16:19]
    v_and_b32_dpp v12, v50, v4 row_newbcast:9 row_mask:0xf bank_mask:0xf
    v_and_b32_dpp v13, v50, v5 row_newbcast:9 row_mask:0xf bank_mask:0xf
    v_and_b32_dpp v14, v50, v6 row_newbcast:9 row_mask:0xf bank_mask:0xf
    v_and_b32_dpp v15, v50, v7 row_newbcast:9 row_mask:0xf bank_mask:0xf
    s_waitcnt vmcnt(15)
    v_mfma_f32_16x16x32_bf16 v[16:19], v[8:11], v[160:163], v[16:19]
    v_and_b32_dpp v8, v50, v4 row_newbcast:10 row_mask:0xf bank_mask:0xf
    v_and_b32_dpp v9, v50, v5 row_newbcast:10 row_mask:0xf bank_mask:0xf
    v_and_b32_dpp v10, v50, v6 row_newbcast:10 row_mask:0xf bank_mask:0xf
    v_and_b32_dpp v11, v50, v7 row_newbcast:10 row_mask:0xf bank_mask:0xf
    s_waitcnt vmcnt(14)
    v_mfma_f32_16x16x32_bf16 v[16:19], v[12:15], v[164:167], v[16:19]
    v_and_b32_dpp v12, v50, v4 row_newbcast:11 row_mask:0xf bank_mask:0xf
    v_and_b32_dpp v13, v50, v5 row_newbcast:11 row_mask:0xf bank_mask:0xf
    v_and_b32_dpp v14, v50, v6 row_newbcast:11 row_mask:0xf bank_mask:0xf
    v_and_b32_dpp v15, v50, v7 row_newbcast:11 row_mask:0xf bank_mask:0xf
    s_waitcnt vmcnt(13)
    v_mfma_f32_16x16x32_bf16 v[16:19], v[8:11], v[168:171], v[16:19]
    v_and_b32_dpp v8, v50, v4 row_newbcast:12 row_mask:0xf bank_mask:0xf
    v_and_b32_dpp v9, v50, v5 row_newbcast:12 row_mask:0xf bank_mask:0xf
    v_and_b32_dpp v10, v50, v6 row_newbcast:12 row_mask:0xf bank_mask:0xf
    v_and_b32_dpp v11, v50, v7 row_newbcast:12 row_mask:0xf bank_mask:0xf
    s_waitcnt vmcnt(12)
    v_mfma_f32_16x16x32_bf16 v[16:19], v[12:15], v[172:175], v[16:19]
    v_and_b32_dpp v12, v50, v4 row_newbcast:13 row_mask:0xf bank_mask:0xf
    v_and_b32_dpp v13, v50, v5 row_newbcast:13 row_mask:0xf bank_mask:0xf
    v_and_b32_dpp v14, v50, v6 row_newbcast:13 row_mask:0xf bank_mask:0xf
    v_and_b32_dpp v15, v50, v7 row_newbcast:13 row_mask:0xf bank_mask:0xf
    s_waitcnt vmcnt(11)
    v_mfma_f32_16x16x32_bf16 v[16:19], v[8:11], v[176:179], v[16:19]
    v_and_b32_dpp v8, v50, v4 row_newbcast:14 row_mask:0xf bank_mask:0xf
    v_and_b32_dpp v9, v50, v5 row_newbcast:14 row_mask:0xf bank_mask:0xf
    v_and_b32_dpp v10, v50, v6 row_newbcast:14 row_mask:0xf bank_mask:0xf
    v_and_b32_dpp v11, v50, v7 row_newbcast:14 row_mask:0xf bank_mask:0xf
    s_waitcnt vmcnt(10)
    v_mfma_f32_16x16x32_bf16 v[16:19], v[12:15], v[180:183], v[16:19]
    v_and_b32_dpp v12, v50, v4 row_newbcast:15 row_mask:0xf bank_mask:0xf
    v_and_b32_dpp v13, v50, v5 row_newbcast:15 row_mask:0xf bank_mask:0xf
    v_and_b32_dpp v14, v50, v6 row_newbcast:15 row_mask:0xf bank_mask:0xf
    v_and_b32_dpp v15, v50, v7 row_newbcast:15 row_mask:0xf bank_mask:0xf
    s_waitcnt vmcnt(9)
    v_mfma_f32_16x16x32_bf16 v[16:19], v[8:11], v[184:187], v[16:19]
    v_and_b32_dpp v8, v51, v4 row_newbcast:0 row_mask:0xf bank_mask:0xf
    v_and_b32_dpp v9, v51, v5 row_newbcast:0 row_mask:0xf bank_mask:0xf
    v_and_b32_dpp v10, v51, v6 row_newbcast:0 row_mask:0xf bank_mask:0xf
    v_and_b32_dpp v11, v51, v7 row_newbcast:0 row_mask:0xf bank_mask:0xf
    s_waitcnt vmcnt(8)
    v_mfma_f32_16x16x32_bf16 v[16:19], v[12:15], v[188:191], v[16:19]
    v_and_b32_dpp v12, v51, v4 row_newbcast:1 row_mask:0xf bank_mask:0xf
    v_and_b32_dpp v13, v51, v5 row_newbcast:1 row_mask:0xf bank_mask:0xf
    v_and_b32_dpp v14, v51, v6 row_newbcast:1 row_mask:0xf bank_mask:0xf
    v_and_b32_dpp v15, v51, v7 row_newbcast:1 row_mask:0xf bank_mask:0xf
    s_waitcnt vmcnt(7)
    v_mfma_f32_16x16x32_bf16 v[16:19], v[8:11], v[192:195], v[16:19]
    v_and_b32_dpp v8, v51, v4 row_newbcast:2 row_mask:0xf bank_mask:0xf
    v_and_b32_dpp v9, v51, v5 row_newbcast:2 row_mask:0xf bank_mask:0xf
    v_and_b32_dpp v10, v51, v6 row_newbcast:2 row_mask:0xf bank_mask:0xf
    v_and_b32_dpp v11, v51, v7 row_newbcast:2 row_mask:0xf bank_mask:0xf
    s_waitcnt vmcnt(6)
    v_mfma_f32_16x16x32_bf16 v[16:19], v[12:15], v[196:199], v[16:19]
    v_and_b32_dpp v12, v51, v4 row_newbcast:3 row_mask:0xf bank_mask:0xf
    v_and_b32_dpp v13, v51, v5 row_newbcast:3 row_mask:0xf bank_mask:0xf
    v_and_b32_dpp v14, v51, v6 row_newbcast:3 row_mask:0xf bank_mask:0xf
    v_and_b32_dpp v15, v51, v7 row_newbcast:3 row_mask:0xf bank_mask:0xf
    s_waitcnt vmcnt(5)
    v_mfma_f32_16x16x32_bf16 v[16:19], v[8:11], v[200:203], v[16:19]
    v_and_b32_dpp v8, v51, v4 row_newbcast:4 row_mask:0xf bank_mask:0xf
    v_and_b32_dpp v9, v51, v5 row_newbcast:4 row_mask:0xf bank_mask:0xf
    v_and_b32_dpp v10, v51, v6 row_newbcast:4 row_mask:0xf bank_mask:0xf
    v_and_b32_dpp v11, v51, v7 row_newbcast:4 row_mask:0xf bank_mask:0xf
    s_waitcnt vmcnt(4)
    v_mfma_f32_16x16x32_bf16 v[16:19], v[12:15], v[204:207], v[16:19]
    v_and_b32_dpp v12, v51, v4 row_newbcast:5 row_mask:0xf bank_mask:0xf
    v_and_b32_dpp v13, v51, v5 row_newbcast:5 row_mask:0xf bank_mask:0xf
    v_and_b32_dpp v14, v51, v6 row_newbcast:5 row_mask:0xf bank_mask:0xf
    v_and_b32_dpp v15, v51, v7 row_newbcast:5 row_mask:0xf bank_mask:0xf
    s_waitcnt vmcnt(3)
    v_mfma_f32_16x16x32_bf16 v[16:19], v[8:11], v[208:211], v[16:19]
    v_and_b32_dpp v8, v51, v4 row_newbcast:6 row_mask:0xf bank_mask:0xf
    v_and_b32_dpp v9, v51, v5 row_newbcast:6 row_mask:0xf bank_mask:0xf
    v_and_b32_dpp v10, v51, v6 row_newbcast:6 row_mask:0xf bank_mask:0xf
    v_and_b32_dpp v11, v51, v7 row_newbcast:6 row_mask:0xf bank_mask:0xf
    s_waitcnt vmcnt(2)
    v_mfma_f32_16x16x32_bf16 v[16:19], v[12:15], v[212:215], v[16:19]
    v_and_b32_dpp v12, v51, v4 row_newbcast:7 row_mask:0xf bank_mask:0xf
    v_and_b32_dpp v13, v51, v5 row_newbcast:7 row_mask:0xf bank_mask:0xf
    v_and_b32_dpp v14, v51, v6 row_newbcast:7 row_mask:0xf bank_mask:0xf
    v_and_b32_dpp v15, v51, v7 row_newbcast:7 row_mask:0xf bank_mask:0xf
    s_waitcnt vmcnt(1)
    v_mfma_f32_16x16x32_bf16 v[16:19], v[8:11], v[216:219], v[16:19]
    s_waitcnt vmcnt(0)
    v_mfma_f32_16x16x32_bf16 v[16:19], v[12:15], v[220:223], v[16:19]
    s_mov_b32 exec_hi, 0
    s_nop 6
    ds_write_b128 v3, v[16:19] offset:0
    s_mov_b32 exec_hi, -1
    s_waitcnt vmcnt(0) lgkmcnt(0)
    s_barrier
    s_cmp_lg_u32 s76, 0
    s_cbranch_scc1 L_NOCNT
    s_lshl_b32 s82, s77, 6
    v_mov_b32 v21, 1
    v_mov_b32 v23, s82
    s_mov_b64 exec, 1
    buffer_atomic_add v21, v23, s[48:51], 0 offen sc1
    s_mov_b64 exec, -1
L_NOCNT:
    s_mul_i32 s82, s8, 5120
    buffer_load_dwordx4 v[224:227], v27, s[20:23], s82 offen offset:0
    buffer_load_dwordx4 v[228:231], v27, s[20:23], s82 offen offset:256
    buffer_load_dwordx4 v[232:235], v27, s[20:23], s82 offen offset:512
    buffer_load_dwordx4 v[236:239], v27, s[20:23], s82 offen offset:768
    buffer_load_dwordx4 v[240:243], v27, s[20:23], s82 offen offset:1024
    s_cmp_ge_u32 s81, 54
    s_cbranch_scc1 L_OWN_1
    s_mul_i32 s9, s77, 165888
    s_mul_i32 s10, s77, 10240
    s_mov_b32 s11, s10
    buffer_load_dwordx4 v[64:67], v44, s[24:27], s9 offen offset:0
    buffer_load_dwordx4 v[104:107], v44, s[28:31], s9 offen offset:0
    s_add_u32 s9, s9, 55296
    s_cmp_eq_u32 s9, 552960
    s_cselect_b32 s9, 0, s9
    buffer_load_dwordx4 v[68:71], v44, s[24:27], s9 offen offset:0
    buffer_load_dwordx4 v[108:111], v44, s[28:31], s9 offen offset:0
    s_add_u32 s9, s9, 55296
    s_cmp_eq_u32 s9, 552960
    s_cselect_b32 s9, 0, s9
    buffer_load_dwordx4 v[72:75], v44, s[24:27], s9 offen offset:0
    buffer_load_dwordx4 v[112:115], v44, s[28:31], s9 offen offset:0
    s_add_u32 s9, s9, 55296
    s_cmp_eq_u32 s9, 552960
    s_cselect_b32 s9, 0, s9
    buffer_load_dwordx4 v[144:147], v45, s[32:35], s10 offen offset:0
    s_add_u32 s10, s10, 5120
    s_cmp_eq_u32 s10, 40960
    s_cselect_b32 s10, 0, s10
    buffer_load_dwordx4 v[148:151], v45, s[32:35], s10 offen offset:0
    s_add_u32 s10, s10, 5120
    s_cmp_eq_u32 s10, 40960
    s_cselect_b32 s10, 0, s10
    s_cmp_lg_u32 s76, 0
    s_cbranch_scc1 L_DN4_2
    buffer_load_dwordx4 v[176:179], v45, s[32:35], s11 offen offset:1024
    s_add_u32 s11, s11, 5120
    s_cmp_eq_u32 s11, 40960
    s_cselect_b32 s11, 0, s11
    buffer_load_dwordx4 v[180:183], v45, s[32:35], s11 offen offset:1024
    s_add_u32 s11, s11, 5120
    s_cmp_eq_u32 s11, 40960
    s_cselect_b32 s11, 0, s11
L_DN4_2:
L_OWN_1:
    s_mul_i32 s83, s8, 1
    s_add_u32 s83, s83, 1
    v_mov_b32 v22, 0
    s_nop 1
L_WP_3:
    s_sleep 4
    ds_read_b32 v25, v22 offset:4144
    s_waitcnt lgkmcnt(0)
    v_cmp_gt_u32 vcc, s83, v25
    s_nop 4
    s_cbranch_vccnz L_WP_3
    s_cmp_ge_u32 s81, 54
    s_cbranch_scc1 L_NOFFN
    buffer_load_dwordx4 v[76:79], v44, s[24:27], s9 offen offset:0
    buffer_load_dwordx4 v[116:119], v44, s[28:31], s9 offen offset:0
    s_add_u32 s9, s9, 55296
    s_cmp_eq_u32 s9, 552960
    s_cselect_b32 s9, 0, s9
    buffer_load_dwordx4 v[80:83], v44, s[24:27], s9 offen offset:0
    buffer_load_dwordx4 v[120:123], v44, s[28:31], s9 offen offset:0
    s_add_u32 s9, s9, 55296
    s_cmp_eq_u32 s9, 552960
    s_cselect_b32 s9, 0, s9
    buffer_load_dwordx4 v[84:87], v44, s[24:27], s9 offen offset:0
    buffer_load_dwordx4 v[124:127], v44, s[28:31], s9 offen offset:0
    s_add_u32 s9, s9, 55296
    s_cmp_eq_u32 s9, 552960
    s_cselect_b32 s9, 0, s9
    buffer_load_dwordx4 v[88:91], v44, s[24:27], s9 offen offset:0
    buffer_load_dwordx4 v[128:131], v44, s[28:31], s9 offen offset:0
    s_add_u32 s9, s9, 55296
    s_cmp_eq_u32 s9, 552960
    s_cselect_b32 s9, 0, s9
    buffer_load_dwordx4 v[92:95], v44, s[24:27], s9 offen offset:0
    buffer_load_dwordx4 v[132:135], v44, s[28:31], s9 offen offset:0
    s_add_u32 s9, s9, 55296
    s_cmp_eq_u32 s9, 552960
    s_cselect_b32 s9, 0, s9
    buffer_load_dwordx4 v[96:99], v44, s[24:27], s9 offen offset:0
    buffer_load_dwordx4 v[136:139], v44, s[28:31], s9 offen offset:0
    s_add_u32 s9, s9, 55296
    s_cmp_eq_u32 s9, 552960
    s_cselect_b32 s9, 0, s9
    buffer_load_dwordx4 v[100:103], v44, s[24:27], s9 offen offset:0
    buffer_load_dwordx4 v[140:143], v44, s[28:31], s9 offen offset:0
    buffer_load_dwordx4 v[152:155], v45, s[32:35], s10 offen offset:0
    s_add_u32 s10, s10, 5120
    s_cmp_eq_u32 s10, 40960
    s_cselect_b32 s10, 0, s10
    buffer_load_dwordx4 v[156:159], v45, s[32:35], s10 offen offset:0
    s_add_u32 s10, s10, 5120
    s_cmp_eq_u32 s10, 40960
    s_cselect_b32 s10, 0, s10
    buffer_load_dwordx4 v[160:163], v45, s[32:35], s10 offen offset:0
    s_add_u32 s10, s10, 5120
    s_cmp_eq_u32 s10, 40960
    s_cselect_b32 s10, 0, s10
    buffer_load_dwordx4 v[164:167], v45, s[32:35], s10 offen offset:0
    s_add_u32 s10, s10, 5120
    s_cmp_eq_u32 s10, 40960
    s_cselect_b32 s10, 0, s10
    buffer_load_dwordx4 v[168:171], v45, s[32:35], s10 offen offset:0
    s_add_u32 s10, s10, 5120
    s_cmp_eq_u32 s10, 40960
    s_cselect_b32 s10, 0, s10
    buffer_load_dwordx4 v[172:175], v45, s[32:35], s10 offen offset:0
    s_cmp_lg_u32 s76, 0
    s_cbranch_scc1 L_DN4_4
    buffer_load_dwordx4 v[184:187], v45, s[32:35], s11 offen offset:1024
    s_add_u32 s11, s11, 5120
    s_cmp_eq_u32 s11, 40960
    s_cselect_b32 s11, 0, s11
    buffer_load_dwordx4 v[188:191], v45, s[32:35], s11 offen offset:1024
    s_add_u32 s11, s11, 5120
    s_cmp_eq_u32 s11, 40960
    s_cselect_b32 s11, 0, s11
    buffer_load_dwordx4 v[192:195], v45, s[32:35], s11 offen offset:1024
    s_add_u32 s11, s11, 5120
    s_cmp_eq_u32 s11, 40960
    s_cselect_b32 s11, 0, s11
    buffer_load_dwordx4 v[196:199], v45, s[32:35], s11 offen offset:1024
    s_add_u32 s11, s11, 5120
    s_cmp_eq_u32 s11, 40960
    s_cselect_b32 s11, 0, s11
    buffer_load_dwordx4 v[200:203], v45, s[32:35], s11 offen offset:1024
    s_add_u32 s11, s11, 5120
    s_cmp_eq_u32 s11, 40960
    s_cselect_b32 s11, 0, s11
    buffer_load_dwordx4 v[204:207], v45, s[32:35], s11 offen offset:1024
L_DN4_4:
    v_lshlrev_b32 v52, 16, v52
    v_sub_f32 v52, v52, v46
    v_cvt_pk_bf16_f32 v52, v52, v52
    v_and_b32 v52, s87, v52
    v_mul_f32 v20, v52, v48
    v_fma_f32 v21, -v20, v47, v52
    v_fmac_f32 v20, v21, v48
    v_cvt_pk_bf16_f32 v52, v20, v20
    v_and_b32 v52, s87, v52
    v_lshlrev_b32 v53, 16, v53
    v_sub_f32 v53, v53, v46
    v_cvt_pk_bf16_f32 v53, v53, v53
    v_and_b32 v53, s87, v53
    v_mul_f32 v20, v53, v48
    v_fma_f32 v21, -v20, v47, v53
    v_fmac_f32 v20, v21, v48
    v_cvt_pk_bf16_f32 v53, v20, v20
    v_and_b32 v53, s87, v53
    v_lshlrev_b32 v54, 16, v54
    v_sub_f32 v54, v54, v46
    v_cvt_pk_bf16_f32 v54, v54, v54
    v_and_b32 v54, s87, v54
    v_mul_f32 v20, v54, v48
    v_fma_f32 v21, -v20, v47, v54
    v_fmac_f32 v20, v21, v48
    v_cvt_pk_bf16_f32 v54, v20, v20
    v_and_b32 v54, s87, v54
    v_lshlrev_b32 v55, 16, v55
    v_sub_f32 v55, v55, v46
    v_cvt_pk_bf16_f32 v55, v55, v55
    v_and_b32 v55, s87, v55
    v_mul_f32 v20, v55, v48
    v_fma_f32 v21, -v20, v47, v55
    v_fmac_f32 v20, v21, v48
    v_cvt_pk_bf16_f32 v55, v20, v20
    v_and_b32 v55, s87, v55
    v_lshlrev_b32 v56, 16, v56
    v_sub_f32 v56, v56, v46
    v_cvt_pk_bf16_f32 v56, v56, v56
    v_and_b32 v56, s87, v56
    v_mul_f32 v20, v56, v48
    v_fma_f32 v21, -v20, v47, v56
    v_fmac_f32 v20, v21, v48
    v_cvt_pk_bf16_f32 v56, v20, v20
    v_and_b32 v56, s87, v56
    v_lshlrev_b32 v57, 16, v57
    v_sub_f32 v57, v57, v46
    v_cvt_pk_bf16_f32 v57, v57, v57
    v_and_b32 v57, s87, v57
    v_mul_f32 v20, v57, v48
    v_fma_f32 v21, -v20, v47, v57
    v_fmac_f32 v20, v21, v48
    v_cvt_pk_bf16_f32 v57, v20, v20
    v_and_b32 v57, s87, v57
    v_lshlrev_b32 v58, 16, v58
    v_sub_f32 v58, v58, v46
    v_cvt_pk_bf16_f32 v58, v58, v58
    v_and_b32 v58, s87, v58
    v_mul_f32 v20, v58, v48
    v_fma_f32 v21, -v20, v47, v58
    v_fmac_f32 v20, v21, v48
    v_cvt_pk_bf16_f32 v58, v20, v20
    v_and_b32 v58, s87, v58
    v_lshlrev_b32 v59, 16, v59
    v_sub_f32 v59, v59, v46
    v_cvt_pk_bf16_f32 v59, v59, v59
    v_and_b32 v59, s87, v59
    v_mul_f32 v20, v59, v48
    v_fma_f32 v21, -v20, v47, v59
    v_fmac_f32 v20, v21, v48
    v_cvt_pk_bf16_f32 v59, v20, v20
    v_and_b32 v59, s87, v59
    v_lshlrev_b32 v60, 16, v60
    v_sub_f32 v60, v60, v46
    v_cvt_pk_bf16_f32 v60, v60, v60
    v_and_b32 v60, s87, v60
    v_mul_f32 v20, v60, v48
    v_fma_f32 v21, -v20, v47, v60
    v_fmac_f32 v20, v21, v48
    v_cvt_pk_bf16_f32 v60, v20, v20
    v_and_b32 v60, s87, v60
    v_lshlrev_b32 v61, 16, v61
    v_sub_f32 v61, v61, v46
    v_cvt_pk_bf16_f32 v61, v61, v61
    v_and_b32 v61, s87, v61
    v_mul_f32 v20, v61, v48
    v_fma_f32 v21, -v20, v47, v61
    v_fmac_f32 v20, v21, v48
    v_cvt_pk_bf16_f32 v61, v20, v20
    v_and_b32 v61, s87, v61
    s_waitcnt vmcnt(0)
    v_lshlrev_b32 v23, 16, v64
    v_and_b32 v24, s87, v64
    v_mul_f32 v28, v52, v23
    v_mul_f32 v29, v52, v24
    v_lshlrev_b32 v20, 16, v65
    v_and_b32 v21, s87, v65
    v_mul_f32 v30, v52, v20
    v_mul_f32 v31, v52, v21
    v_lshlrev_b32 v23, 16, v66
    v_and_b32 v24, s87, v66
    v_mul_f32 v32, v52, v23
    v_mul_f32 v33, v52, v24
    v_lshlrev_b32 v20, 16, v67
    v_and_b32 v21, s87, v67
    v_mul_f32 v34, v52, v20
    v_mul_f32 v35, v52, v21
    v_lshlrev_b32 v23, 16, v68
    v_and_b32 v24, s87, v68
    v_fmac_f32 v28, v53, v23
    v_fmac_f32 v29, v53, v24
    v_lshlrev_b32 v20, 16, v69
    v_and_b32 v21, s87, v69
    v_fmac_f32 v30, v53, v20
    v_fmac_f32 v31, v53, v21
    v_lshlrev_b32 v23, 16, v70
    v_and_b32 v24, s87, v70
    v_fmac_f32 v32, v53, v23
    v_fmac_f32 v33, v53, v24
    v_lshlrev_b32 v20, 16, v71
    v_and_b32 v21, s87, v71
    v_fmac_f32 v34, v53, v20
    v_fmac_f32 v35, v53, v21
    v_lshlrev_b32 v23, 16, v72
    v_and_b32 v24, s87, v72
    v_fmac_f32 v28, v54, v23
    v_fmac_f32 v29, v54, v24
    v_lshlrev_b32 v20, 16, v73
    v_and_b32 v21, s87, v73
    v_fmac_f32 v30, v54, v20
    v_fmac_f32 v31, v54, v21
    v_lshlrev_b32 v23, 16, v74
    v_and_b32 v24, s87, v74
    v_fmac_f32 v32, v54, v23
    v_fmac_f32 v33, v54, v24
    v_lshlrev_b32 v20, 16, v75
    v_and_b32 v21, s87, v75
    v_fmac_f32 v34, v54, v20
    v_fmac_f32 v35, v54, v21
    v_lshlrev_b32 v23, 16, v76
    v_and_b32 v24, s87, v76
    v_fmac_f32 v28, v55, v23
    v_fmac_f32 v29, v55, v24
    v_lshlrev_b32 v20, 16, v77
    v_and_b32 v21, s87, v77
    v_fmac_f32 v30, v55, v20
    v_fmac_f32 v31, v55, v21
    v_lshlrev_b32 v23, 16, v78
    v_and_b32 v24, s87, v78
    v_fmac_f32 v32, v55, v23
    v_fmac_f32 v33, v55, v24
    v_lshlrev_b32 v20, 16, v79
    v_and_b32 v21, s87, v79
    v_fmac_f32 v34, v55, v20
    v_fmac_f32 v35, v55, v21
    v_lshlrev_b32 v23, 16, v80
    v_and_b32 v24, s87, v80
    v_fmac_f32 v28, v56, v23
    v_fmac_f32 v29, v56, v24
    v_lshlrev_b32 v20, 16, v81
    v_and_b32 v21, s87, v81
    v_fmac_f32 v30, v56, v20
    v_fmac_f32 v31, v56, v21
    v_lshlrev_b32 v23, 16, v82
    v_and_b32 v24, s87, v82
    v_fmac_f32 v32, v56, v23
    v_fmac_f32 v33, v56, v24
    v_lshlrev_b32 v20, 16, v83
    v_and_b32 v21, s87, v83
    v_fmac_f32 v34, v56, v20
    v_fmac_f32 v35, v56, v21
    v_lshlrev_b32 v23, 16, v84
    v_and_b32 v24, s87, v84
    v_fmac_f32 v28, v57, v23
    v_fmac_f32 v29, v57, v24
    v_lshlrev_b32 v20, 16, v85
    v_and_b32 v21, s87, v85
    v_fmac_f32 v30, v57, v20
    v_fmac_f32 v31, v57, v21
    v_lshlrev_b32 v23, 16, v86
    v_and_b32 v24, s87, v86
    v_fmac_f32 v32, v57, v23
    v_fmac_f32 v33, v57, v24
    v_lshlrev_b32 v20, 16, v87
    v_and_b32 v21, s87, v87
    v_fmac_f32 v34, v57, v20
    v_fmac_f32 v35, v57, v21
    v_lshlrev_b32 v23, 16, v88
    v_and_b32 v24, s87, v88
    v_fmac_f32 v28, v58, v23
    v_fmac_f32 v29, v58, v24
    v_lshlrev_b32 v20, 16, v89
    v_and_b32 v21, s87, v89
    v_fmac_f32 v30, v58, v20
    v_fmac_f32 v31, v58, v21
    v_lshlrev_b32 v23, 16, v90
    v_and_b32 v24, s87, v90
    v_fmac_f32 v32, v58, v23
    v_fmac_f32 v33, v58, v24
    v_lshlrev_b32 v20, 16, v91
    v_and_b32 v21, s87, v91
    v_fmac_f32 v34, v58, v20
    v_fmac_f32 v35, v58, v21
    v_lshlrev_b32 v23, 16, v92
    v_and_b32 v24, s87, v92
    v_fmac_f32 v28, v59, v23
    v_fmac_f32 v29, v59, v24
    v_lshlrev_b32 v20, 16, v93
    v_and_b32 v21, s87, v93
    v_fmac_f32 v30, v59, v20
    v_fmac_f32 v31, v59, v21
    v_lshlrev_b32 v23, 16, v94
    v_and_b32 v24, s87, v94
    v_fmac_f32 v32, v59, v23
    v_fmac_f32 v33, v59, v24
    v_lshlrev_b32 v20, 16, v95
    v_and_b32 v21, s87, v95
    v_fmac_f32 v34, v59, v20
    v_fmac_f32 v35, v59, v21
    v_lshlrev_b32 v23, 16, v96
    v_and_b32 v24, s87, v96
    v_fmac_f32 v28, v60, v23
    v_fmac_f32 v29, v60, v24
    v_lshlrev_b32 v20, 16, v97
    v_and_b32 v21, s87, v97
    v_fmac_f32 v30, v60, v20
    v_fmac_f32 v31, v60, v21
    v_lshlrev_b32 v23, 16, v98
    v_and_b32 v24, s87, v98
    v_fmac_f32 v32, v60, v23
    v_fmac_f32 v33, v60, v24
    v_lshlrev_b32 v20, 16, v99
    v_and_b32 v21, s87, v99
    v_fmac_f32 v34, v60, v20
    v_fmac_f32 v35, v60, v21
    v_lshlrev_b32 v23, 16, v100
    v_and_b32 v24, s87, v100
    v_fmac_f32 v28, v61, v23
    v_fmac_f32 v29, v61, v24
    v_lshlrev_b32 v20, 16, v101
    v_and_b32 v21, s87, v101
    v_fmac_f32 v30, v61, v20
    v_fmac_f32 v31, v61, v21
    v_lshlrev_b32 v23, 16, v102
    v_and_b32 v24, s87, v102
    v_fmac_f32 v32, v61, v23
    v_fmac_f32 v33, v61, v24
    v_lshlrev_b32 v20, 16, v103
    v_and_b32 v21, s87, v103
    v_fmac_f32 v34, v61, v20
    v_fmac_f32 v35, v61, v21
    v_lshlrev_b32 v23, 16, v104
    v_and_b32 v24, s87, v104
    v_mul_f32 v36, v52, v23
    v_mul_f32 v37, v52, v24
    v_lshlrev_b32 v20, 16, v105
    v_and_b32 v21, s87, v105
    v_mul_f32 v38, v52, v20
    v_mul_f32 v39, v52, v21
    v_lshlrev_b32 v23, 16, v106
    v_and_b32 v24, s87, v106
    v_mul_f32 v40, v52, v23
    v_mul_f32 v41, v52, v24
    v_lshlrev_b32 v20, 16, v107
    v_and_b32 v21, s87, v107
    v_mul_f32 v42, v52, v20
    v_mul_f32 v43, v52, v21
    v_lshlrev_b32 v23, 16, v108
    v_and_b32 v24, s87, v108
    v_fmac_f32 v36, v53, v23
    v_fmac_f32 v37, v53, v24
    v_lshlrev_b32 v20, 16, v109
    v_and_b32 v21, s87, v109
    v_fmac_f32 v38, v53, v20
    v_fmac_f32 v39, v53, v21
    v_lshlrev_b32 v23, 16, v110
    v_and_b32 v24, s87, v110
    v_fmac_f32 v40, v53, v23
    v_fmac_f32 v41, v53, v24
    v_lshlrev_b32 v20, 16, v111
    v_and_b32 v21, s87, v111
    v_fmac_f32 v42, v53, v20
    v_fmac_f32 v43, v53, v21
    v_lshlrev_b32 v23, 16, v112
    v_and_b32 v24, s87, v112
    v_fmac_f32 v36, v54, v23
    v_fmac_f32 v37, v54, v24
    v_lshlrev_b32 v20, 16, v113
    v_and_b32 v21, s87, v113
    v_fmac_f32 v38, v54, v20
    v_fmac_f32 v39, v54, v21
    v_lshlrev_b32 v23, 16, v114
    v_and_b32 v24, s87, v114
    v_fmac_f32 v40, v54, v23
    v_fmac_f32 v41, v54, v24
    v_lshlrev_b32 v20, 16, v115
    v_and_b32 v21, s87, v115
    v_fmac_f32 v42, v54, v20
    v_fmac_f32 v43, v54, v21
    v_lshlrev_b32 v23, 16, v116
    v_and_b32 v24, s87, v116
    v_fmac_f32 v36, v55, v23
    v_fmac_f32 v37, v55, v24
    v_lshlrev_b32 v20, 16, v117
    v_and_b32 v21, s87, v117
    v_fmac_f32 v38, v55, v20
    v_fmac_f32 v39, v55, v21
    v_lshlrev_b32 v23, 16, v118
    v_and_b32 v24, s87, v118
    v_fmac_f32 v40, v55, v23
    v_fmac_f32 v41, v55, v24
    v_lshlrev_b32 v20, 16, v119
    v_and_b32 v21, s87, v119
    v_fmac_f32 v42, v55, v20
    v_fmac_f32 v43, v55, v21
    v_lshlrev_b32 v23, 16, v120
    v_and_b32 v24, s87, v120
    v_fmac_f32 v36, v56, v23
    v_fmac_f32 v37, v56, v24
    v_lshlrev_b32 v20, 16, v121
    v_and_b32 v21, s87, v121
    v_fmac_f32 v38, v56, v20
    v_fmac_f32 v39, v56, v21
    v_lshlrev_b32 v23, 16, v122
    v_and_b32 v24, s87, v122
    v_fmac_f32 v40, v56, v23
    v_fmac_f32 v41, v56, v24
    v_lshlrev_b32 v20, 16, v123
    v_and_b32 v21, s87, v123
    v_fmac_f32 v42, v56, v20
    v_fmac_f32 v43, v56, v21
    v_lshlrev_b32 v23, 16, v124
    v_and_b32 v24, s87, v124
    v_fmac_f32 v36, v57, v23
    v_fmac_f32 v37, v57, v24
    v_lshlrev_b32 v20, 16, v125
    v_and_b32 v21, s87, v125
    v_fmac_f32 v38, v57, v20
    v_fmac_f32 v39, v57, v21
    v_lshlrev_b32 v23, 16, v126
    v_and_b32 v24, s87, v126
    v_fmac_f32 v40, v57, v23
    v_fmac_f32 v41, v57, v24
    v_lshlrev_b32 v20, 16, v127
    v_and_b32 v21, s87, v127
    v_fmac_f32 v42, v57, v20
    v_fmac_f32 v43, v57, v21
    v_lshlrev_b32 v23, 16, v128
    v_and_b32 v24, s87, v128
    v_fmac_f32 v36, v58, v23
    v_fmac_f32 v37, v58, v24
    v_lshlrev_b32 v20, 16, v129
    v_and_b32 v21, s87, v129
    v_fmac_f32 v38, v58, v20
    v_fmac_f32 v39, v58, v21
    v_lshlrev_b32 v23, 16, v130
    v_and_b32 v24, s87, v130
    v_fmac_f32 v40, v58, v23
    v_fmac_f32 v41, v58, v24
    v_lshlrev_b32 v20, 16, v131
    v_and_b32 v21, s87, v131
    v_fmac_f32 v42, v58, v20
    v_fmac_f32 v43, v58, v21
    v_lshlrev_b32 v23, 16, v132
    v_and_b32 v24, s87, v132
    v_fmac_f32 v36, v59, v23
    v_fmac_f32 v37, v59, v24
    v_lshlrev_b32 v20, 16, v133
    v_and_b32 v21, s87, v133
    v_fmac_f32 v38, v59, v20
    v_fmac_f32 v39, v59, v21
    v_lshlrev_b32 v23, 16, v134
    v_and_b32 v24, s87, v134
    v_fmac_f32 v40, v59, v23
    v_fmac_f32 v41, v59, v24
    v_lshlrev_b32 v20, 16, v135
    v_and_b32 v21, s87, v135
    v_fmac_f32 v42, v59, v20
    v_fmac_f32 v43, v59, v21
    v_lshlrev_b32 v23, 16, v136
    v_and_b32 v24, s87, v136
    v_fmac_f32 v36, v60, v23
    v_fmac_f32 v37, v60, v24
    v_lshlrev_b32 v20, 16, v137
    v_and_b32 v21, s87, v137
    v_fmac_f32 v38, v60, v20
    v_fmac_f32 v39, v60, v21
    v_lshlrev_b32 v23, 16, v138
    v_and_b32 v24, s87, v138
    v_fmac_f32 v40, v60, v23
    v_fmac_f32 v41, v60, v24
    v_lshlrev_b32 v20, 16, v139
    v_and_b32 v21, s87, v139
    v_fmac_f32 v42, v60, v20
    v_fmac_f32 v43, v60, v21
    v_lshlrev_b32 v23, 16, v140
    v_and_b32 v24, s87, v140
    v_fmac_f32 v36, v61, v23
    v_fmac_f32 v37, v61, v24
    v_lshlrev_b32 v20, 16, v141
    v_and_b32 v21, s87, v141
    v_fmac_f32 v38, v61, v20
    v_fmac_f32 v39, v61, v21
    v_lshlrev_b32 v23, 16, v142
    v_and_b32 v24, s87, v142
    v_fmac_f32 v40, v61, v23
    v_fmac_f32 v41, v61, v24
    v_lshlrev_b32 v20, 16, v143
    v_and_b32 v21, s87, v143
    v_fmac_f32 v42, v61, v20
    v_fmac_f32 v43, v61, v21
    v_add_f32_dpp v28, v28, v28 row_ror:8 row_mask:0xf bank_mask:0x3
    v_add_f32_dpp v29, v29, v29 row_ror:8 row_mask:0xf bank_mask:0x3
    v_add_f32_dpp v30, v30, v30 row_ror:8 row_mask:0xf bank_mask:0x3
    v_add_f32_dpp v31, v31, v31 row_ror:8 row_mask:0xf bank_mask:0x3
    v_add_f32_dpp v32, v32, v32 row_ror:8 row_mask:0xf bank_mask:0x3
    v_add_f32_dpp v33, v33, v33 row_ror:8 row_mask:0xf bank_mask:0x3
    v_add_f32_dpp v34, v34, v34 row_ror:8 row_mask:0xf bank_mask:0x3
    v_add_f32_dpp v35, v35, v35 row_ror:8 row_mask:0xf bank_mask:0x3
    v_add_f32_dpp v28, v36, v36 row_ror:8 row_mask:0xf bank_mask:0xc
    v_add_f32_dpp v29, v37, v37 row_ror:8 row_mask:0xf bank_mask:0xc
    v_add_f32_dpp v30, v38, v38 row_ror:8 row_mask:0xf bank_mask:0xc
    v_add_f32_dpp v31, v39, v39 row_ror:8 row_mask:0xf bank_mask:0xc
    v_add_f32_dpp v32, v40, v40 row_ror:8 row_mask:0xf bank_mask:0xc
    v_add_f32_dpp v33, v41, v41 row_ror:8 row_mask:0xf bank_mask:0xc
    v_add_f32_dpp v34, v42, v42 row_ror:8 row_mask:0xf bank_mask:0xc
    v_add_f32_dpp v35, v43, v43 row_ror:8 row_mask:0xf bank_mask:0xc
    v_add_f32_dpp v28, v28, v28 row_shl:4 row_mask:0xf bank_mask:0x5
    v_add_f32_dpp v29, v29, v29 row_shl:4 row_mask:0xf bank_mask:0x5
    v_add_f32_dpp v30, v30, v30 row_shl:4 row_mask:0xf bank_mask:0x5
    v_add_f32_dpp v31, v31, v31 row_shl:4 row_mask:0xf bank_mask:0x5
    v_add_f32_dpp v28, v32, v32 row_shr:4 row_mask:0xf bank_mask:0xa
    v_add_f32_dpp v29, v33, v33 row_shr:4 row_mask:0xf bank_mask:0xa
    v_add_f32_dpp v30, v34, v34 row_shr:4 row_mask:0xf bank_mask:0xa
    v_add_f32_dpp v31, v35, v35 row_shr:4 row_mask:0xf bank_mask:0xa
    s_nop 0
    v_permlane16_swap_b32 v28, v30
    v_permlane16_swap_b32 v29, v31
    v_add_f32 v28, v28, v30
    v_add_f32 v29, v29, v31
    s_nop 1
    v_permlane32_swap_b32 v28, v29
    v_add_f32 v28, v28, v29
    v_bfe_u32 v20, v0, 3, 1
    v_lshlrev_b32 v20, 5, v20
    v_and_b32 v21, 3, v0
    v_lshl_add_u32 v20, v21, 3, v20
    v_bfe_u32 v21, v0, 5, 1
    v_add_u32 v20, v20, v21
    v_bfe_u32 v21, v0, 4, 1
    v_lshl_add_u32 v20, v21, 1, v20
    v_and_b32 v21, 4, v0
    v_add_u32 v20, v20, v21
    v_lshrrev_b32 v21, 6, v0
    v_lshl_add_u32 v20, v20, 2, v21
    v_lshlrev_b32 v20, 2, v20
    ds_write_b32 v20, v28 offset:3072
    v_mov_b32 v22, 0
    v_mov_b32 v23, 1
    s_waitcnt lgkmcnt(0)
    s_mov_b64 exec, 1
    ds_add_u32 v22, v23 offset:4128
    s_mov_b64 exec, -1
    v_and_b32 v20, 15, v0
    v_bfe_u32 v21, v0, 4, 2
    s_mul_i32 s82, s77, 2
    v_add_u32 v23, s82, v20
    v_and_b32 v23, 7, v23
    v_and_b32 v24, 8, v20
    v_or_b32 v23, v23, v24
    v_lshl_add_u32 v23, v23, 2, v21
    v_lshlrev_b32 v23, 4, v23
    s_nop 1
L_FSPIN:
    ds_read_b32 v25, v22 offset:4128
    s_waitcnt lgkmcnt(0)
    v_cmp_gt_u32 vcc, 4, v25
    s_nop 4
    s_cbranch_vccz L_FGO
    s_sleep 1
    s_branch L_FSPIN
L_FGO:
    ds_read_b128 v[28:31], v23 offset:3072
    s_waitcnt lgkmcnt(0)
    v_add_f32 v28, v28, v29
    v_add_f32 v30, v30, v31
    v_add_f32 v28, v28, v30
    v_cvt_pk_bf16_f32 v28, v28, v28
    v_and_b32 v28, s87, v28
    s_nop 1
    v_mul_f32_dpp v29, v28, v28 row_ror:8 row_mask:0xf bank_mask:0xf
    v_cvt_pk_bf16_f32 v29, v29, v29
    s_nop 1
    v_and_b32_dpp v8, v29, v4 row_newbcast:0 row_mask:0xf bank_mask:0xf
    v_and_b32_dpp v9, v29, v5 row_newbcast:0 row_mask:0xf bank_mask:0xf
    v_and_b32_dpp v10, v29, v6 row_newbcast:0 row_mask:0xf bank_mask:0xf
    v_and_b32_dpp v11, v29, v7 row_newbcast:0 row_mask:0xf bank_mask:0xf
    s_nop 1
    v_mfma_f32_16x16x32_bf16 v[52:55], v[8:11], v[144:147], 0
    v_and_b32_dpp v12, v29, v4 row_newbcast:1 row_mask:0xf bank_mask:0xf
    v_and_b32_dpp v13, v29, v5 row_newbcast:1 row_mask:0xf bank_mask:0xf
    v_and_b32_dpp v14, v29, v6 row_newbcast:1 row_mask:0xf bank_mask:0xf
    v_and_b32_dpp v15, v29, v7 row_newbcast:1 row_mask:0xf bank_mask:0xf
    s_nop 1
    v_mfma_f32_16x16x32_bf16 v[52:55], v[12:15], v[148:151], v[52:55]
    v_and_b32_dpp v8, v29, v4 row_newbcast:2 row_mask:0xf bank_mask:0xf
    v_and_b32_dpp v9, v29, v5 row_newbcast:2 row_mask:0xf bank_mask:0xf
    v_and_b32_dpp v10, v29, v6 row_newbcast:2 row_mask:0xf bank_mask:0xf
    v_and_b32_dpp v11, v29, v7 row_newbcast:2 row_mask:0xf bank_mask:0xf
    s_nop 1
    v_mfma_f32_16x16x32_bf16 v[52:55], v[8:11], v[152:155], v[52:55]
    v_and_b32_dpp v12, v29, v4 row_newbcast:3 row_mask:0xf bank_mask:0xf
    v_and_b32_dpp v13, v29, v5 row_newbcast:3 row_mask:0xf bank_mask:0xf
    v_and_b32_dpp v14, v29, v6 row_newbcast:3 row_mask:0xf bank_mask:0xf
    v_and_b32_dpp v15, v29, v7 row_newbcast:3 row_mask:0xf bank_mask:0xf
    s_nop 1
    v_mfma_f32_16x16x32_bf16 v[52:55], v[12:15], v[156:159], v[52:55]
    v_and_b32_dpp v8, v29, v4 row_newbcast:4 row_mask:0xf bank_mask:0xf
    v_and_b32_dpp v9, v29, v5 row_newbcast:4 row_mask:0xf bank_mask:0xf
    v_and_b32_dpp v10, v29, v6 row_newbcast:4 row_mask:0xf bank_mask:0xf
    v_and_b32_dpp v11, v29, v7 row_newbcast:4 row_mask:0xf bank_mask:0xf
    s_nop 1
    v_mfma_f32_16x16x32_bf16 v[52:55], v[8:11], v[160:163], v[52:55]
    v_and_b32_dpp v12, v29, v4 row_newbcast:5 row_mask:0xf bank_mask:0xf
    v_and_b32_dpp v13, v29, v5 row_newbcast:5 row_mask:0xf bank_mask:0xf
    v_and_b32_dpp v14, v29, v6 row_newbcast:5 row_mask:0xf bank_mask:0xf
    v_and_b32_dpp v15, v29, v7 row_newbcast:5 row_mask:0xf bank_mask:0xf
    s_nop 1
    v_mfma_f32_16x16x32_bf16 v[52:55], v[12:15], v[164:167], v[52:55]
    v_and_b32_dpp v8, v29, v4 row_newbcast:6 row_mask:0xf bank_mask:0xf
    v_and_b32_dpp v9, v29, v5 row_newbcast:6 row_mask:0xf bank_mask:0xf
    v_and_b32_dpp v10, v29, v6 row_newbcast:6 row_mask:0xf bank_mask:0xf
    v_and_b32_dpp v11, v29, v7 row_newbcast:6 row_mask:0xf bank_mask:0xf
    s_nop 1
    v_mfma_f32_16x16x32_bf16 v[52:55], v[8:11], v[168:171], v[52:55]
    v_and_b32_dpp v12, v29, v4 row_newbcast:7 row_mask:0xf bank_mask:0xf
    v_and_b32_dpp v13, v29, v5 row_newbcast:7 row_mask:0xf bank_mask:0xf
    v_and_b32_dpp v14, v29, v6 row_newbcast:7 row_mask:0xf bank_mask:0xf
    v_and_b32_dpp v15, v29, v7 row_newbcast:7 row_mask:0xf bank_mask:0xf
    s_nop 1
    v_mfma_f32_16x16x32_bf16 v[52:55], v[12:15], v[172:175], v[52:55]
    s_nop 7
    v_min_u32 v52, -2, v52
    v_min_u32 v53, -2, v53
    v_min_u32 v54, -2, v54
    v_min_u32 v55, -2, v55
    s_cmp_lg_u32 s76, 0
    s_nop 0
    s_cbranch_scc1 L_NOFFN
    v_and_b32_dpp v8, v29, v4 row_newbcast:0 row_mask:0xf bank_mask:0xf
    v_and_b32_dpp v9, v29, v5 row_newbcast:0 row_mask:0xf bank_mask:0xf
    v_and_b32_dpp v10, v29, v6 row_newbcast:0 row_mask:0xf bank_mask:0xf
    v_and_b32_dpp v11, v29, v7 row_newbcast:0 row_mask:0xf bank_mask:0xf
    s_nop 1
    v_mfma_f32_16x16x32_bf16 v[56:59], v[8:11], v[176:179], 0
    v_and_b32_dpp v12, v29, v4 row_newbcast:1 row_mask:0xf bank_mask:0xf
    v_and_b32_dpp v13, v29, v5 row_newbcast:1 row_mask:0xf bank_mask:0xf
    v_and_b32_dpp v14, v29, v6 row_newbcast:1 row_mask:0xf bank_mask:0xf
    v_and_b32_dpp v15, v29, v7 row_newbcast:1 row_mask:0xf bank_mask:0xf
    s_nop 1
    v_mfma_f32_16x16x32_bf16 v[56:59], v[12:15], v[180:183], v[56:59]
    v_and_b32_dpp v8, v29, v4 row_newbcast:2 row_mask:0xf bank_mask:0xf
    v_and_b32_dpp v9, v29, v5 row_newbcast:2 row_mask:0xf bank_mask:0xf
    v_and_b32_dpp v10, v29, v6 row_newbcast:2 row_mask:0xf bank_mask:0xf
    v_and_b32_dpp v11, v29, v7 row_newbcast:2 row_mask:0xf bank_mask:0xf
    s_nop 1
    v_mfma_f32_16x16x32_bf16 v[56:59], v[8:11], v[184:187], v[56:59]
    v_and_b32_dpp v12, v29, v4 row_newbcast:3 row_mask:0xf bank_mask:0xf
    v_and_b32_dpp v13, v29, v5 row_newbcast:3 row_mask:0xf bank_mask:0xf
    v_and_b32_dpp v14, v29, v6 row_newbcast:3 row_mask:0xf bank_mask:0xf
    v_and_b32_dpp v15, v29, v7 row_newbcast:3 row_mask:0xf bank_mask:0xf
    s_nop 1
    v_mfma_f32_16x16x32_bf16 v[56:59], v[12:15], v[188:191], v[56:59]
    v_and_b32_dpp v8, v29, v4 row_newbcast:4 row_mask:0xf bank_mask:0xf
    v_and_b32_dpp v9, v29, v5 row_newbcast:4 row_mask:0xf bank_mask:0xf
    v_and_b32_dpp v10, v29, v6 row_newbcast:4 row_mask:0xf bank_mask:0xf
    v_and_b32_dpp v11, v29, v7 row_newbcast:4 row_mask:0xf bank_mask:0xf
    s_nop 1
    v_mfma_f32_16x16x32_bf16 v[56:59], v[8:11], v[192:195], v[56:59]
    v_and_b32_dpp v12, v29, v4 row_newbcast:5 row_mask:0xf bank_mask:0xf
    v_and_b32_dpp v13, v29, v5 row_newbcast:5 row_mask:0xf bank_mask:0xf
    v_and_b32_dpp v14, v29, v6 row_newbcast:5 row_mask:0xf bank_mask:0xf
    v_and_b32_dpp v15, v29, v7 row_newbcast:5 row_mask:0xf bank_mask:0xf
    s_nop 1
    v_mfma_f32_16x16x32_bf16 v[56:59], v[12:15], v[196:199], v[56:59]
    v_and_b32_dpp v8, v29, v4 row_newbcast:6 row_mask:0xf bank_mask:0xf
    v_and_b32_dpp v9, v29, v5 row_newbcast:6 row_mask:0xf bank_mask:0xf
    v_and_b32_dpp v10, v29, v6 row_newbcast:6 row_mask:0xf bank_mask:0xf
    v_and_b32_dpp v11, v29, v7 row_newbcast:6 row_mask:0xf bank_mask:0xf
    s_nop 1
    v_mfma_f32_16x16x32_bf16 v[56:59], v[8:11], v[200:203], v[56:59]
    v_and_b32_dpp v12, v29, v4 row_newbcast:7 row_mask:0xf bank_mask:0xf
    v_and_b32_dpp v13, v29, v5 row_newbcast:7 row_mask:0xf bank_mask:0xf
    v_and_b32_dpp v14, v29, v6 row_newbcast:7 row_mask:0xf bank_mask:0xf
    v_and_b32_dpp v15, v29, v7 row_newbcast:7 row_mask:0xf bank_mask:0xf
    s_nop 1
    v_mfma_f32_16x16x32_bf16 v[56:59], v[12:15], v[204:207], v[56:59]
    s_nop 7
    v_min_u32 v56, -2, v56
    v_min_u32 v57, -2, v57
    v_min_u32 v58, -2, v58
    v_min_u32 v59, -2, v59
    s_nop 1
L_NOFFN:
    s_mul_i32 s82, s8, 5120
    buffer_load_dwordx4 v[64:67], v27, s[20:23], s82 offen offset:0
    buffer_load_dwordx4 v[68:71], v27, s[20:23], s82 offen offset:256
    buffer_load_dwordx4 v[72:75], v27, s[20:23], s82 offen offset:512
    buffer_load_dwordx4 v[76:79], v27, s[20:23], s82 offen offset:768
    buffer_load_dwordx4 v[80:83], v27, s[20:23], s82 offen offset:1024
    s_add_u32 s82, s82, 5120
    s_cmp_eq_u32 s82, 40960
    s_cselect_b32 s82, 0, s82
    buffer_load_dwordx4 v[84:87], v27, s[20:23], s82 offen offset:0
    buffer_load_dwordx4 v[88:91], v27, s[20:23], s82 offen offset:256
    buffer_load_dwordx4 v[92:95], v27, s[20:23], s82 offen offset:512
    buffer_load_dwordx4 v[96:99], v27, s[20:23], s82 offen offset:768
    buffer_load_dwordx4 v[100:103], v27, s[20:23], s82 offen offset:1024
    s_add_u32 s82, s82, 5120
    s_cmp_eq_u32 s82, 40960
    s_cselect_b32 s82, 0, s82
    buffer_load_dwordx4 v[104:107], v27, s[20:23], s82 offen offset:0
    buffer_load_dwordx4 v[108:111], v27, s[20:23], s82 offen offset:256
    buffer_load_dwordx4 v[112:115], v27, s[20:23], s82 offen offset:512
    buffer_load_dwordx4 v[116:119], v27, s[20:23], s82 offen offset:768
    buffer_load_dwordx4 v[120:123], v27, s[20:23], s82 offen offset:1024
    s_add_u32 s82, s82, 5120
    s_cmp_eq_u32 s82, 40960
    s_cselect_b32 s82, 0, s82
    buffer_load_dwordx4 v[124:127], v27, s[20:23], s82 offen offset:0
    buffer_load_dwordx4 v[128:131], v27, s[20:23], s82 offen offset:256
    buffer_load_dwordx4 v[132:135], v27, s[20:23], s82 offen offset:512
    buffer_load_dwordx4 v[136:139], v27, s[20:23], s82 offen offset:768
    buffer_load_dwordx4 v[140:143], v27, s[20:23], s82 offen offset:1024
    s_add_u32 s82, s82, 5120
    s_cmp_eq_u32 s82, 40960
    s_cselect_b32 s82, 0, s82
    buffer_load_dwordx4 v[144:147], v27, s[20:23], s82 offen offset:0
    buffer_load_dwordx4 v[148:151], v27, s[20:23], s82 offen offset:256
    buffer_load_dwordx4 v[152:155], v27, s[20:23], s82 offen offset:512
    buffer_load_dwordx4 v[156:159], v27, s[20:23], s82 offen offset:768
    buffer_load_dwordx4 v[160:163], v27, s[20:23], s82 offen offset:1024
    s_add_u32 s82, s82, 5120
    s_cmp_eq_u32 s82, 40960
    s_cselect_b32 s82, 0, s82
    buffer_load_dwordx4 v[164:167], v27, s[20:23], s82 offen offset:0
    buffer_load_dwordx4 v[168:171], v27, s[20:23], s82 offen offset:256
    buffer_load_dwordx4 v[172:175], v27, s[20:23], s82 offen offset:512
    buffer_load_dwordx4 v[176:179], v27, s[20:23], s82 offen offset:768
    buffer_load_dwordx4 v[180:183], v27, s[20:23], s82 offen offset:1024
    s_add_u32 s82, s82, 5120
    s_cmp_eq_u32 s82, 40960
    s_cselect_b32 s82, 0, s82
    buffer_load_dwordx4 v[184:187], v27, s[20:23], s82 offen offset:0
    buffer_load_dwordx4 v[188:191], v27, s[20:23], s82 offen offset:256
    buffer_load_dwordx4 v[192:195], v27, s[20:23], s82 offen offset:512
    buffer_load_dwordx4 v[196:199], v27, s[20:23], s82 offen offset:768
    buffer_load_dwordx4 v[200:203], v27, s[20:23], s82 offen offset:1024
    s_add_u32 s82, s82, 5120
    s_cmp_eq_u32 s82, 40960
    s_cselect_b32 s82, 0, s82
    buffer_load_dwordx4 v[204:207], v27, s[20:23], s82 offen offset:0
    buffer_load_dwordx4 v[208:211], v27, s[20:23], s82 offen offset:256
    buffer_load_dwordx4 v[212:215], v27, s[20:23], s82 offen offset:512
    buffer_load_dwordx4 v[216:219], v27, s[20:23], s82 offen offset:768
    buffer_load_dwordx4 v[220:223], v27, s[20:23], s82 offen offset:1024
    s_cmp_lg_u32 s76, 3
    s_cbranch_scc1 L_NORED1
    s_cmp_ge_u32 s80, 40
    s_cbranch_scc1 L_NORED1
    v_and_b32 v44, 3, v0
    v_lshlrev_b32 v44, 3, v44
    s_lshl_b32 s97, s80, 5
    buffer_load_dwordx2 v[248:249], v44, s[36:39], s97 offen
    v_lshrrev_b32 v45, 2, v1
    v_mul_u32_u24 v26, 10240, v45
    v_lshl_add_u32 v26, v44, 1, v26
    v_lshlrev_b32 v45, 5, v45
    s_mul_i32 s84, s77, 163840
    s_lshl_b32 s82, s80, 6
    s_add_u32 s84, s84, s82
    s_add_u32 s9, s84, 5120
    s_add_u32 s92, s84, 655360
    s_add_u32 s93, s9, 655360
    s_lshl_b32 s85, s77, 9
    s_add_u32 s85, s85, 1310720
    v_mov_b32 v20, 0x7ffffff0
    v_cmp_gt_u32 vcc, 56, v1
    v_cmp_gt_u32 s[94:95], 52, v1
    s_lshl_b32 s82, s77, 6
    v_mov_b32 v24, s82
    v_cndmask_b32 v22, v20, v26, vcc
    v_cndmask_b32 v23, v20, v26, s[94:95]
    s_mov_b32 s86, 0
    s_nop 0
L_POLL0:
    buffer_load_dword v25, v24, s[48:51], 0 offen sc1
    s_add_u32 s86, s86, 1
    s_waitcnt vmcnt(0)
    v_cmp_gt_u32 vcc, 64, v25
    s_nop 4
    s_cbranch_vccz L_POLL1
    s_sleep 8
    s_cmp_lt_u32 s86, 0x40000
    s_cbranch_scc1 L_POLL0
L_POLL1:
    v_mov_b32 v49, v22
    v_mov_b32 v50, v23
    s_mov_b32 s10, s92
    s_mov_b32 s11, s93
    v_lshlrev_b32 v250, 16, v249
    v_and_b32 v251, s87, v249
    v_and_b32 v249, s87, v248
    v_lshlrev_b32 v248, 16, v248
    s_nop 1
L_NORED1:
    v_bfe_u32 v21, v0, 3, 1
    v_mul_u32_u24 v21, 1088, v21
    v_lshrrev_b32 v20, 6, v0
    v_lshl_add_u32 v21, v20, 7, v21
    v_add_u32 v23, s8, v0
    v_and_b32 v23, 7, v23
    v_lshl_add_u32 v21, v23, 4, v21
    v_bfe_u32 v23, v0, 4, 2
    v_lshl_add_u32 v21, v23, 2, v21
    v_mov_b32 v23, 0
    v_lshl_add_u32 v22, v20, 11, v3
    s_mov_b32 s88, 0xff00ff00
    s_mov_b32 s89, 0xff00ff00
L_MLW:
    s_sleep 8
    ds_read_b128 v[28:31], v23 offset:4144
    s_waitcnt lgkmcnt(0)
    v_min_u32 v28, v28, v29
    v_min3_u32 v28, v28, v30, v31
    v_cmp_gt_u32 vcc, 10, v28
    s_nop 4
    s_cbranch_vccnz L_MLW
    ds_read_b128 v[28:31], v23 offset:4096
    ds_read_b128 v[32:35], v23 offset:4112
    s_waitcnt lgkmcnt(0)
    v_max_f32 v36, v28, v29
    v_max3_f32 v36, v36, v30, v31
    v_sub_f32 v28, v28, v36
    v_sub_f32 v29, v29, v36
    v_sub_f32 v30, v30, v36
    v_sub_f32 v31, v31, v36
    v_mul_f32 v28, 0x3fb8aa3b, v28
    v_mul_f32 v29, 0x3fb8aa3b, v29
    v_mul_f32 v30, 0x3fb8aa3b, v30
    v_mul_f32 v31, 0x3fb8aa3b, v31
    v_exp_f32 v28, v28
    v_exp_f32 v29, v29
    v_exp_f32 v30, v30
    v_exp_f32 v31, v31
    v_mul_f32 v37, v28, v32
    v_fmac_f32 v37, v29, v33
    v_fmac_f32 v37, v30, v34
    v_fmac_f32 v37, v31, v35
    v_cndmask_b32 v28, v28, v30, s[88:89]
    v_cndmask_b32 v29, v29, v31, s[88:89]
    v_rcp_f32 v48, v37
    v_min_u32 v36, -2, v36
    v_min_u32 v37, -2, v37
    v_mov_b32 v38, 0
    v_mov_b32 v39, 0
    v_mul_f32 v62, v28, v48
    v_mul_f32 v63, v29, v48
    s_waitcnt vmcnt(0)
    s_barrier
    ds_read_b32 v24, v21 offset:4352
    ds_read_b32 v25, v21 offset:4896
    s_cmp_lg_u32 s76, 3
    s_cbranch_scc1 L_NOML
    s_mov_b64 exec, 1
    buffer_store_dwordx2 v[36:37], v252, s[44:47], 0 offen sc1
    s_mov_b64 exec, -1
L_NOML:
    s_cmp_ge_u32 s81, 54
    s_cbranch_scc1 L_NOFP
    s_mov_b32 exec_hi, 0
    buffer_store_dwordx4 v[52:55], v3, s[44:47], s96 offen sc1
    s_cmp_lg_u32 s76, 0
    s_nop 0
    s_cbranch_scc1 L_NOFP
    buffer_store_dwordx4 v[56:59], v3, s[44:47], s96 offen offset:2048 sc1
    s_nop 1
L_NOFP:
    s_mov_b32 exec_hi, -1
    s_waitcnt lgkmcnt(0)
    v_mul_f32 v24, v24, v62
    v_fmac_f32 v24, v25, v63
    s_nop 1
    v_add_f32_dpp v24, v24, v24 row_ror:8 row_mask:0xf bank_mask:0xf
    v_cvt_pk_bf16_f32 v24, v24, v24
    s_nop 1
    v_and_b32_dpp v8, v24, v4 row_newbcast:0 row_mask:0xf bank_mask:0xf
    v_and_b32_dpp v9, v24, v5 row_newbcast:0 row_mask:0xf bank_mask:0xf
    v_and_b32_dpp v10, v24, v6 row_newbcast:0 row_mask:0xf bank_mask:0xf
    v_and_b32_dpp v11, v24, v7 row_newbcast:0 row_mask:0xf bank_mask:0xf
    v_and_b32_dpp v12, v24, v4 row_newbcast:1 row_mask:0xf bank_mask:0xf
    v_and_b32_dpp v13, v24, v5 row_newbcast:1 row_mask:0xf bank_mask:0xf
    v_and_b32_dpp v14, v24, v6 row_newbcast:1 row_mask:0xf bank_mask:0xf
    v_and_b32_dpp v15, v24, v7 row_newbcast:1 row_mask:0xf bank_mask:0xf
    v_mfma_f32_16x16x32_bf16 v[224:227], v[8:11], v[64:67], 0
    v_mfma_f32_16x16x32_bf16 v[228:231], v[8:11], v[68:71], 0
    v_mfma_f32_16x16x32_bf16 v[232:235], v[8:11], v[72:75], 0
    v_mfma_f32_16x16x32_bf16 v[236:239], v[8:11], v[76:79], 0
    v_mfma_f32_16x16x32_bf16 v[240:243], v[8:11], v[80:83], 0
    v_and_b32_dpp v8, v24, v4 row_newbcast:2 row_mask:0xf bank_mask:0xf
    v_and_b32_dpp v9, v24, v5 row_newbcast:2 row_mask:0xf bank_mask:0xf
    v_and_b32_dpp v10, v24, v6 row_newbcast:2 row_mask:0xf bank_mask:0xf
    v_and_b32_dpp v11, v24, v7 row_newbcast:2 row_mask:0xf bank_mask:0xf
    v_mfma_f32_16x16x32_bf16 v[224:227], v[12:15], v[84:87], v[224:227]
    v_mfma_f32_16x16x32_bf16 v[228:231], v[12:15], v[88:91], v[228:231]
    v_mfma_f32_16x16x32_bf16 v[232:235], v[12:15], v[92:95], v[232:235]
    v_mfma_f32_16x16x32_bf16 v[236:239], v[12:15], v[96:99], v[236:239]
    v_mfma_f32_16x16x32_bf16 v[240:243], v[12:15], v[100:103], v[240:243]
    v_and_b32_dpp v12, v24, v4 row_newbcast:3 row_mask:0xf bank_mask:0xf
    v_and_b32_dpp v13, v24, v5 row_newbcast:3 row_mask:0xf bank_mask:0xf
    v_and_b32_dpp v14, v24, v6 row_newbcast:3 row_mask:0xf bank_mask:0xf
    v_and_b32_dpp v15, v24, v7 row_newbcast:3 row_mask:0xf bank_mask:0xf
    v_mfma_f32_16x16x32_bf16 v[224:227], v[8:11], v[104:107], v[224:227]
    v_mfma_f32_16x16x32_bf16 v[228:231], v[8:11], v[108:111], v[228:231]
    v_mfma_f32_16x16x32_bf16 v[232:235], v[8:11], v[112:115], v[232:235]
    v_mfma_f32_16x16x32_bf16 v[236:239], v[8:11], v[116:119], v[236:239]
    v_mfma_f32_16x16x32_bf16 v[240:243], v[8:11], v[120:123], v[240:243]
    v_and_b32_dpp v8, v24, v4 row_newbcast:4 row_mask:0xf bank_mask:0xf
    v_and_b32_dpp v9, v24, v5 row_newbcast:4 row_mask:0xf bank_mask:0xf
    v_and_b32_dpp v10, v24, v6 row_newbcast:4 row_mask:0xf bank_mask:0xf
    v_and_b32_dpp v11, v24, v7 row_newbcast:4 row_mask:0xf bank_mask:0xf
    v_mfma_f32_16x16x32_bf16 v[224:227], v[12:15], v[124:127], v[224:227]
    v_mfma_f32_16x16x32_bf16 v[228:231], v[12:15], v[128:131], v[228:231]
    v_mfma_f32_16x16x32_bf16 v[232:235], v[12:15], v[132:135], v[232:235]
    v_mfma_f32_16x16x32_bf16 v[236:239], v[12:15], v[136:139], v[236:239]
    v_mfma_f32_16x16x32_bf16 v[240:243], v[12:15], v[140:143], v[240:243]
    v_and_b32_dpp v12, v24, v4 row_newbcast:5 row_mask:0xf bank_mask:0xf
    v_and_b32_dpp v13, v24, v5 row_newbcast:5 row_mask:0xf bank_mask:0xf
    v_and_b32_dpp v14, v24, v6 row_newbcast:5 row_mask:0xf bank_mask:0xf
    v_and_b32_dpp v15, v24, v7 row_newbcast:5 row_mask:0xf bank_mask:0xf
    v_mfma_f32_16x16x32_bf16 v[224:227], v[8:11], v[144:147], v[224:227]
    v_mfma_f32_16x16x32_bf16 v[228:231], v[8:11], v[148:151], v[228:231]
    v_mfma_f32_16x16x32_bf16 v[232:235], v[8:11], v[152:155], v[232:235]
    v_mfma_f32_16x16x32_bf16 v[236:239], v[8:11], v[156:159], v[236:239]
    v_mfma_f32_16x16x32_bf16 v[240:243], v[8:11], v[160:163], v[240:243]
    v_and_b32_dpp v8, v24, v4 row_newbcast:6 row_mask:0xf bank_mask:0xf
    v_and_b32_dpp v9, v24, v5 row_newbcast:6 row_mask:0xf bank_mask:0xf
    v_and_b32_dpp v10, v24, v6 row_newbcast:6 row_mask:0xf bank_mask:0xf
    v_and_b32_dpp v11, v24, v7 row_newbcast:6 row_mask:0xf bank_mask:0xf
    v_mfma_f32_16x16x32_bf16 v[224:227], v[12:15], v[164:167], v[224:227]
    v_mfma_f32_16x16x32_bf16 v[228:231], v[12:15], v[168:171], v[228:231]
    v_mfma_f32_16x16x32_bf16 v[232:235], v[12:15], v[172:175], v[232:235]
    v_mfma_f32_16x16x32_bf16 v[236:239], v[12:15], v[176:179], v[236:239]
    v_mfma_f32_16x16x32_bf16 v[240:243], v[12:15], v[180:183], v[240:243]
    v_and_b32_dpp v12, v24, v4 row_newbcast:7 row_mask:0xf bank_mask:0xf
    v_and_b32_dpp v13, v24, v5 row_newbcast:7 row_mask:0xf bank_mask:0xf
    v_and_b32_dpp v14, v24, v6 row_newbcast:7 row_mask:0xf bank_mask:0xf
    v_and_b32_dpp v15, v24, v7 row_newbcast:7 row_mask:0xf bank_mask:0xf
    v_mfma_f32_16x16x32_bf16 v[224:227], v[8:11], v[184:187], v[224:227]
    v_mfma_f32_16x16x32_bf16 v[228:231], v[8:11], v[188:191], v[228:231]
    v_mfma_f32_16x16x32_bf16 v[232:235], v[8:11], v[192:195], v[232:235]
    v_mfma_f32_16x16x32_bf16 v[236:239], v[8:11], v[196:199], v[236:239]
    v_mfma_f32_16x16x32_bf16 v[240:243], v[8:11], v[200:203], v[240:243]
    v_mfma_f32_16x16x32_bf16 v[224:227], v[12:15], v[204:207], v[224:227]
    v_mfma_f32_16x16x32_bf16 v[228:231], v[12:15], v[208:211], v[228:231]
    v_mfma_f32_16x16x32_bf16 v[232:235], v[12:15], v[212:215], v[232:235]
    v_mfma_f32_16x16x32_bf16 v[236:239], v[12:15], v[216:219], v[236:239]
    v_mfma_f32_16x16x32_bf16 v[240:243], v[12:15], v[220:223], v[240:243]
    s_mov_b32 exec_hi, 0
    s_nop 2
    ds_write_b128 v22, v[224:227] offset:6656
    ds_write_b128 v22, v[228:231] offset:7168
    ds_write_b128 v22, v[232:235] offset:7680
    ds_write_b128 v22, v[236:239] offset:8192
    ds_write_b128 v22, v[240:243] offset:8704
    s_mov_b32 exec_hi, -1
    s_waitcnt lgkmcnt(0)
    s_barrier
    s_cmp_lg_u32 s76, 3
    s_cbranch_scc1 L_FIN
    s_cmp_ge_u32 s80, 40
    s_cbranch_scc1 L_FIN
L_POLL2:
    buffer_load_dwordx4 v[80:83], v45, s[44:47], s85 offen offset:0 sc1
    buffer_load_dwordx4 v[84:87], v45, s[44:47], s85 offen offset:16 sc1
    s_add_u32 s86, s86, 1
    s_waitcnt vmcnt(0)
    v_max3_u32 v25, v80, v81, v82
    v_max3_u32 v25, v25, v83, v84
    v_max3_u32 v25, v25, v85, v86
    v_max_u32 v25, v25, v87
    v_cmp_eq_u32 vcc, -1, v25
    s_nop 4
    s_cbranch_vccz L_MLOK
    s_sleep 4
    s_cmp_lt_u32 s86, 0x40000
    s_cbranch_scc1 L_POLL2
L_MLOK:
    buffer_load_dwordx4 v[88:91], v49, s[44:47], s10 offen offset:0 sc1
    buffer_load_dwordx4 v[92:95], v49, s[44:47], s10 offen offset:2560 sc1
    buffer_load_dwordx4 v[96:99], v50, s[44:47], s11 offen offset:0 sc1
    buffer_load_dwordx4 v[100:103], v50, s[44:47], s11 offen offset:2560 sc1
    buffer_load_dwordx4 v[64:67], v26, s[44:47], s84 offen offset:0 sc1
    buffer_load_dwordx4 v[68:71], v26, s[44:47], s84 offen offset:2560 sc1
    buffer_load_dwordx4 v[72:75], v26, s[44:47], s9 offen offset:0 sc1
    buffer_load_dwordx4 v[76:79], v26, s[44:47], s9 offen offset:2560 sc1
    v_max_f32 v23, v80, v82
    v_max_f32 v24, v84, v86
    v_sub_f32 v80, v80, v23
    v_sub_f32 v82, v82, v23
    v_sub_f32 v84, v84, v24
    v_sub_f32 v86, v86, v24
    v_mul_f32 v80, 0x3fb8aa3b, v80
    v_mul_f32 v82, 0x3fb8aa3b, v82
    v_mul_f32 v84, 0x3fb8aa3b, v84
    v_mul_f32 v86, 0x3fb8aa3b, v86
    v_exp_f32 v80, v80
    v_exp_f32 v82, v82
    v_exp_f32 v84, v84
    v_exp_f32 v86, v86
    v_mul_f32 v80, v80, v81
    v_mul_f32 v82, v82, v83
    v_mul_f32 v84, v84, v85
    v_mul_f32 v86, v86, v87
    v_add_f32 v23, v80, v82
    v_add_f32 v24, v84, v86
    v_rcp_f32 v23, v23
    v_rcp_f32 v24, v24
    v_mul_f32 v104, v80, v23
    v_mul_f32 v105, v82, v23
    v_mul_f32 v106, v84, v24
    v_mul_f32 v107, v86, v24
    s_nop 1
L_POLLF:
    s_waitcnt vmcnt(4)
    v_max3_u32 v25, v88, v89, v90
    v_max3_u32 v25, v25, v91, v92
    v_max3_u32 v25, v25, v93, v94
    v_max3_u32 v25, v25, v95, v96
    v_max3_u32 v25, v25, v97, v98
    v_max3_u32 v25, v25, v99, v100
    v_max3_u32 v25, v25, v101, v102
    v_max_u32 v25, v25, v103
    v_cmp_eq_u32 vcc, -1, v25
    s_nop 4
    s_cbranch_vccz L_FOK
    s_waitcnt vmcnt(0)
    buffer_load_dwordx4 v[88:91], v49, s[44:47], s10 offen offset:0 sc1
    buffer_load_dwordx4 v[92:95], v49, s[44:47], s10 offen offset:2560 sc1
    buffer_load_dwordx4 v[96:99], v50, s[44:47], s11 offen offset:0 sc1
    buffer_load_dwordx4 v[100:103], v50, s[44:47], s11 offen offset:2560 sc1
    buffer_load_dwordx4 v[64:67], v26, s[44:47], s84 offen offset:0 sc1
    buffer_load_dwordx4 v[68:71], v26, s[44:47], s84 offen offset:2560 sc1
    buffer_load_dwordx4 v[72:75], v26, s[44:47], s9 offen offset:0 sc1
    buffer_load_dwordx4 v[76:79], v26, s[44:47], s9 offen offset:2560 sc1
    s_add_u32 s86, s86, 1
    s_cmp_lt_u32 s86, 0x40000
    s_cbranch_scc1 L_POLLF
L_FOK:
    v_add_f32 v244, v88, v92
    v_add_f32 v96, v96, v100
    v_add_f32 v245, v89, v93
    v_add_f32 v97, v97, v101
    v_add_f32 v246, v90, v94
    v_add_f32 v98, v98, v102
    v_add_f32 v247, v91, v95
    v_add_f32 v99, v99, v103
    v_add_f32 v244, v244, v96
    v_add_f32 v245, v245, v97
    v_add_f32 v246, v246, v98
    v_add_f32 v247, v247, v99
    v_add_f32_dpp v244, v244, v244 row_ror:4 row_mask:0xf bank_mask:0xf
    v_add_f32_dpp v245, v245, v245 row_ror:4 row_mask:0xf bank_mask:0xf
    v_add_f32_dpp v246, v246, v246 row_ror:4 row_mask:0xf bank_mask:0xf
    v_add_f32_dpp v247, v247, v247 row_ror:4 row_mask:0xf bank_mask:0xf
    v_add_f32_dpp v244, v244, v244 row_ror:8 row_mask:0xf bank_mask:0xf
    v_add_f32_dpp v245, v245, v245 row_ror:8 row_mask:0xf bank_mask:0xf
    v_add_f32_dpp v246, v246, v246 row_ror:8 row_mask:0xf bank_mask:0xf
    v_add_f32_dpp v247, v247, v247 row_ror:8 row_mask:0xf bank_mask:0xf
    v_mov_b32 v88, v244
    v_mov_b32 v89, v245
    v_mov_b32 v90, v246
    v_mov_b32 v91, v247
    v_permlane16_swap_b32 v88, v244
    v_permlane16_swap_b32 v89, v245
    v_permlane16_swap_b32 v90, v246
    v_permlane16_swap_b32 v91, v247
    v_add_f32 v244, v244, v88
    v_add_f32 v245, v245, v89
    v_add_f32 v246, v246, v90
    v_add_f32 v247, v247, v91
    v_mov_b32 v88, v244
    v_mov_b32 v89, v245
    v_mov_b32 v90, v246
    v_mov_b32 v91, v247
    v_permlane32_swap_b32 v88, v244
    v_permlane32_swap_b32 v89, v245
    v_permlane32_swap_b32 v90, v246
    v_permlane32_swap_b32 v91, v247
    v_add_f32 v244, v244, v88
    v_add_f32 v245, v245, v89
    v_add_f32 v246, v246, v90
    v_add_f32 v247, v247, v91
    v_cvt_pk_bf16_f32 v244, v244, v245
    v_cvt_pk_bf16_f32 v246, v246, v247
    v_and_b32 v245, s87, v244
    v_lshlrev_b32 v244, 16, v244
    v_and_b32 v247, s87, v246
    v_lshlrev_b32 v246, 16, v246
    s_nop 1
L_POLLY:
    s_waitcnt vmcnt(0)
    v_max3_u32 v25, v64, v65, v66
    v_max3_u32 v25, v25, v67, v68
    v_max3_u32 v25, v25, v69, v70
    v_max3_u32 v25, v25, v71, v72
    v_max3_u32 v25, v25, v73, v74
    v_max3_u32 v25, v25, v75, v76
    v_max3_u32 v25, v25, v77, v78
    v_max_u32 v25, v25, v79
    v_cmp_eq_u32 vcc, -1, v25
    s_nop 4
    s_cbranch_vccz L_ATTOK
    buffer_load_dwordx4 v[64:67], v26, s[44:47], s84 offen offset:0 sc1
    buffer_load_dwordx4 v[68:71], v26, s[44:47], s84 offen offset:2560 sc1
    buffer_load_dwordx4 v[72:75], v26, s[44:47], s9 offen offset:0 sc1
    buffer_load_dwordx4 v[76:79], v26, s[44:47], s9 offen offset:2560 sc1
    s_add_u32 s86, s86, 1
    s_cmp_lt_u32 s86, 0x40000
    s_cbranch_scc1 L_POLLY
    s_waitcnt vmcnt(0)
L_ATTOK:
    v_mul_f32 v108, v104, v64
    v_mul_f32 v109, v104, v65
    v_mul_f32 v110, v104, v66
    v_mul_f32 v111, v104, v67
    v_fmac_f32 v108, v105, v68
    v_fmac_f32 v109, v105, v69
    v_fmac_f32 v110, v105, v70
    v_fmac_f32 v111, v105, v71
    v_fmac_f32 v108, v106, v72
    v_fmac_f32 v109, v106, v73
    v_fmac_f32 v110, v106, v74
    v_fmac_f32 v111, v106, v75
    v_fmac_f32 v108, v107, v76
    v_fmac_f32 v109, v107, v77
    v_fmac_f32 v110, v107, v78
    v_fmac_f32 v111, v107, v79
    v_add_f32_dpp v108, v108, v108 row_ror:4 row_mask:0xf bank_mask:0xf
    v_add_f32_dpp v109, v109, v109 row_ror:4 row_mask:0xf bank_mask:0xf
    v_add_f32_dpp v110, v110, v110 row_ror:4 row_mask:0xf bank_mask:0xf
    v_add_f32_dpp v111, v111, v111 row_ror:4 row_mask:0xf bank_mask:0xf
    v_add_f32_dpp v108, v108, v108 row_ror:8 row_mask:0xf bank_mask:0xf
    v_add_f32_dpp v109, v109, v109 row_ror:8 row_mask:0xf bank_mask:0xf
    v_add_f32_dpp v110, v110, v110 row_ror:8 row_mask:0xf bank_mask:0xf
    v_add_f32_dpp v111, v111, v111 row_ror:8 row_mask:0xf bank_mask:0xf
    v_mov_b32 v112, v108
    v_mov_b32 v113, v109
    v_mov_b32 v114, v110
    v_mov_b32 v115, v111
    v_permlane16_swap_b32 v112, v108
    v_permlane16_swap_b32 v113, v109
    v_permlane16_swap_b32 v114, v110
    v_permlane16_swap_b32 v115, v111
    v_add_f32 v108, v108, v112
    v_add_f32 v109, v109, v113
    v_add_f32 v110, v110, v114
    v_add_f32 v111, v111, v115
    v_mov_b32 v112, v108
    v_mov_b32 v113, v109
    v_mov_b32 v114, v110
    v_mov_b32 v115, v111
    v_permlane32_swap_b32 v112, v108
    v_permlane32_swap_b32 v113, v109
    v_permlane32_swap_b32 v114, v110
    v_permlane32_swap_b32 v115, v111
    v_add_f32 v108, v108, v112
    v_add_f32 v109, v109, v113
    v_add_f32 v110, v110, v114
    v_add_f32 v111, v111, v115
    v_cvt_pk_bf16_f32 v108, v108, v109
    v_cvt_pk_bf16_f32 v110, v110, v111
    v_and_b32 v109, s87, v108
    v_lshlrev_b32 v108, 16, v108
    v_and_b32 v111, s87, v110
    v_lshlrev_b32 v110, 16, v110
    v_add_f32 v108, v108, v248
    v_add_f32 v109, v109, v249
    v_add_f32 v110, v110, v250
    v_add_f32 v111, v111, v251
    v_cvt_pk_bf16_f32 v108, v108, v109
    v_cvt_pk_bf16_f32 v110, v110, v111
    v_and_b32 v109, s87, v108
    v_lshlrev_b32 v108, 16, v108
    v_and_b32 v111, s87, v110
    v_lshlrev_b32 v110, 16, v110
    v_add_f32 v108, v108, v244
    v_add_f32 v109, v109, v245
    v_add_f32 v110, v110, v246
    v_add_f32 v111, v111, v247
    v_cvt_pk_bf16_f32 v108, v108, v109
    v_cvt_pk_bf16_f32 v109, v110, v111
    s_mov_b64 exec, 15
    buffer_store_dwordx2 v[108:109], v44, s[40:43], s97 offen
    s_mov_b64 exec, -1
    s_branch L_FIN
L_SWAVE:
    s_lshl_b32 s82, s77, 5
    s_add_u32 s82, s82, s78
    s_lshl_b32 s82, s82, 1
    s_add_u32 s82, s82, s79
    s_lshl_b32 s82, s82, 19
    v_and_b32 v26, 0xff, v0
    v_lshlrev_b32 v26, 4, v26
    s_mov_b32 s84, 0
    s_mov_b32 s85, 4096
    s_waitcnt lgkmcnt(0)
    s_add_u32 s4, s54, s82
    s_addc_u32 s5, s55, 0
    s_mov_b32 s6, 0x80000
    s_mov_b32 s7, 0x20000
    buffer_load_dwordx4 v[64:67], v26, s[4:7], s84 offen nt
    s_add_u32 s84, s84, s85
    buffer_load_dwordx4 v[68:71], v26, s[4:7], s84 offen nt
    s_add_u32 s84, s84, s85
    buffer_load_dwordx4 v[72:75], v26, s[4:7], s84 offen nt
    s_add_u32 s84, s84, s85
    buffer_load_dwordx4 v[76:79], v26, s[4:7], s84 offen nt
    s_add_u32 s84, s84, s85
    buffer_load_dwordx4 v[80:83], v26, s[4:7], s84 offen nt
    s_add_u32 s84, s84, s85
    buffer_load_dwordx4 v[84:87], v26, s[4:7], s84 offen nt
    s_add_u32 s84, s84, s85
    buffer_load_dwordx4 v[88:91], v26, s[4:7], s84 offen nt
    s_add_u32 s84, s84, s85
    buffer_load_dwordx4 v[92:95], v26, s[4:7], s84 offen nt
    s_add_u32 s84, s84, s85
    buffer_load_dwordx4 v[96:99], v26, s[4:7], s84 offen nt
    s_add_u32 s84, s84, s85
    buffer_load_dwordx4 v[100:103], v26, s[4:7], s84 offen nt
    s_add_u32 s84, s84, s85
    s_add_u32 s12, s56, s82
    s_addc_u32 s13, s57, 0
    s_mov_b32 s14, 0x80000
    s_mov_b32 s15, 0x20000
    s_mov_b32 s44, s74
    s_mov_b32 s45, s75
    s_mov_b32 s46, 0x141000
    s_mov_b32 s47, 0x20000
    s_mov_b32 s88, 0xcccccccc
    s_mov_b32 s89, 0xcccccccc
    s_mov_b32 s90, 0xaaaaaaaa
    s_mov_b32 s91, 0xaaaaaaaa
    v_and_b32 v23, 1, v0
    v_lshlrev_b32 v23, 4, v23
    v_mov_b32 v24, 0xffff
    v_lshlrev_b32 v23, v23, v24
    v_bfe_u32 v24, v0, 1, 3
    v_cmp_eq_u32 vcc, 0, v24
    s_nop 1
    v_cndmask_b32 v4, 0, v23, vcc
    v_cmp_eq_u32 vcc, 1, v24
    s_nop 1
    v_cndmask_b32 v5, 0, v23, vcc
    v_cmp_eq_u32 vcc, 2, v24
    s_nop 1
    v_cndmask_b32 v6, 0, v23, vcc
    v_cmp_eq_u32 vcc, 3, v24
    s_nop 1
    v_cndmask_b32 v7, 0, v23, vcc
    s_lshl_b32 s82, s77, 6
    s_add_u32 s96, s82, s81
    s_mul_i32 s96, s96, 2560
    s_add_u32 s96, s96, 655360
    s_add_u32 s82, s82, s80
    s_mul_i32 s83, s82, 2560
    s_lshl_b32 s82, s82, 3
    s_add_u32 s82, s82, 1310720
    v_and_b32 v22, 0xff, v0
    v_lshlrev_b32 v24, 4, v22
    v_cmp_gt_u32 vcc, 160, v22
    v_mov_b32 v25, 0x7ffffff0
    v_add_u32 v24, s83, v24
    v_cndmask_b32 v2, v25, v24, vcc
    v_and_b32 v23, 15, v0
    v_bfe_u32 v24, v0, 4, 2
    v_bfe_u32 v25, v0, 6, 2
    v_lshlrev_b32 v3, 5, v23
    v_lshl_add_u32 v3, v24, 4, v3
    v_lshl_add_u32 v3, v25, 9, v3
    v_lshlrev_b32 v23, 3, v1
    v_bfe_u32 v20, v0, 6, 2
    v_lshlrev_b32 v56, 2, v20
    v_mov_b32 v27, 0
    v_lshlrev_b32 v24, 8, v20
    v_lshl_add_u32 v25, v1, 2, v24
    v_and_b32 v22, 15, v0
    v_lshl_add_u32 v24, v22, 4, v24
    s_barrier
    buffer_load_dwordx4 v[104:107], v26, s[4:7], s84 offen nt
    s_add_u32 s84, s84, s85
    buffer_load_dwordx4 v[108:111], v26, s[4:7], s84 offen nt
    s_add_u32 s84, s84, s85
    buffer_load_dwordx4 v[112:115], v26, s[4:7], s84 offen nt
    s_add_u32 s84, s84, s85
    buffer_load_dwordx4 v[116:119], v26, s[4:7], s84 offen nt
    s_add_u32 s84, s84, s85
    buffer_load_dwordx4 v[120:123], v26, s[4:7], s84 offen nt
    s_add_u32 s84, s84, s85
    buffer_load_dwordx4 v[124:127], v26, s[4:7], s84 offen nt
    s_add_u32 s84, s84, s85
    s_barrier
    ds_read_b64 v[28:29], v23 offset:0
    ds_read_b64 v[30:31], v23 offset:512
    ds_read_b64 v[32:33], v23 offset:1024
    ds_read_b64 v[34:35], v23 offset:1536
    s_waitcnt lgkmcnt(0)
    v_add_f32 v28, v28, v32
    v_add_f32 v29, v29, v33
    v_add_f32 v30, v30, v34
    v_add_f32 v31, v31, v35
    v_add_f32 v28, v28, v30
    v_add_f32 v29, v29, v31
    v_cvt_pk_bf16_f32 v28, v28, v29
    ds_write_b32 v25, v28 offset:2048
    s_waitcnt lgkmcnt(0)
    ds_read_b128 v[44:47], v24 offset:2048
    s_mov_b32 s86, 0
    s_waitcnt lgkmcnt(0)
L_KLOOP:
    s_cmp_eq_u32 s86, 7
    s_cselect_b32 s4, s12, s4
    s_cselect_b32 s5, s13, s5
    s_cselect_b32 s84, 0, s84
    s_waitcnt vmcnt(15)
    v_dot2_f32_bf16 v28, v64, v44, 0
    v_dot2_f32_bf16 v28, v65, v45, v28
    v_dot2_f32_bf16 v28, v66, v46, v28
    v_dot2_f32_bf16 v28, v67, v47, v28
    buffer_load_dwordx4 v[64:67], v26, s[4:7], s84 offen nt
    s_add_u32 s84, s84, s85
    s_waitcnt vmcnt(15)
    v_dot2_f32_bf16 v29, v68, v44, 0
    v_dot2_f32_bf16 v29, v69, v45, v29
    v_dot2_f32_bf16 v29, v70, v46, v29
    v_dot2_f32_bf16 v29, v71, v47, v29
    buffer_load_dwordx4 v[68:71], v26, s[4:7], s84 offen nt
    s_add_u32 s84, s84, s85
    s_waitcnt vmcnt(15)
    v_dot2_f32_bf16 v30, v72, v44, 0
    v_dot2_f32_bf16 v30, v73, v45, v30
    v_dot2_f32_bf16 v30, v74, v46, v30
    v_dot2_f32_bf16 v30, v75, v47, v30
    buffer_load_dwordx4 v[72:75], v26, s[4:7], s84 offen nt
    s_add_u32 s84, s84, s85
    s_waitcnt vmcnt(15)
    v_dot2_f32_bf16 v31, v76, v44, 0
    v_dot2_f32_bf16 v31, v77, v45, v31
    v_dot2_f32_bf16 v31, v78, v46, v31
    v_dot2_f32_bf16 v31, v79, v47, v31
    buffer_load_dwordx4 v[76:79], v26, s[4:7], s84 offen nt
    s_add_u32 s84, s84, s85
    s_waitcnt vmcnt(15)
    v_dot2_f32_bf16 v32, v80, v44, 0
    v_dot2_f32_bf16 v32, v81, v45, v32
    v_dot2_f32_bf16 v32, v82, v46, v32
    v_dot2_f32_bf16 v32, v83, v47, v32
    buffer_load_dwordx4 v[80:83], v26, s[4:7], s84 offen nt
    s_add_u32 s84, s84, s85
    s_waitcnt vmcnt(15)
    v_dot2_f32_bf16 v33, v84, v44, 0
    v_dot2_f32_bf16 v33, v85, v45, v33
    v_dot2_f32_bf16 v33, v86, v46, v33
    v_dot2_f32_bf16 v33, v87, v47, v33
    buffer_load_dwordx4 v[84:87], v26, s[4:7], s84 offen nt
    s_add_u32 s84, s84, s85
    s_waitcnt vmcnt(15)
    v_dot2_f32_bf16 v34, v88, v44, 0
    v_dot2_f32_bf16 v34, v89, v45, v34
    v_dot2_f32_bf16 v34, v90, v46, v34
    v_dot2_f32_bf16 v34, v91, v47, v34
    buffer_load_dwordx4 v[88:91], v26, s[4:7], s84 offen nt
    s_add_u32 s84, s84, s85
    s_waitcnt vmcnt(15)
    v_dot2_f32_bf16 v35, v92, v44, 0
    v_dot2_f32_bf16 v35, v93, v45, v35
    v_dot2_f32_bf16 v35, v94, v46, v35
    v_dot2_f32_bf16 v35, v95, v47, v35
    buffer_load_dwordx4 v[92:95], v26, s[4:7], s84 offen nt
    s_add_u32 s84, s84, s85
    s_waitcnt vmcnt(15)
    v_dot2_f32_bf16 v36, v96, v44, 0
    v_dot2_f32_bf16 v36, v97, v45, v36
    v_dot2_f32_bf16 v36, v98, v46, v36
    v_dot2_f32_bf16 v36, v99, v47, v36
    buffer_load_dwordx4 v[96:99], v26, s[4:7], s84 offen nt
    s_add_u32 s84, s84, s85
    s_waitcnt vmcnt(15)
    v_dot2_f32_bf16 v37, v100, v44, 0
    v_dot2_f32_bf16 v37, v101, v45, v37
    v_dot2_f32_bf16 v37, v102, v46, v37
    v_dot2_f32_bf16 v37, v103, v47, v37
    buffer_load_dwordx4 v[100:103], v26, s[4:7], s84 offen nt
    s_add_u32 s84, s84, s85
    s_waitcnt vmcnt(15)
    v_dot2_f32_bf16 v38, v104, v44, 0
    v_dot2_f32_bf16 v38, v105, v45, v38
    v_dot2_f32_bf16 v38, v106, v46, v38
    v_dot2_f32_bf16 v38, v107, v47, v38
    buffer_load_dwordx4 v[104:107], v26, s[4:7], s84 offen nt
    s_add_u32 s84, s84, s85
    s_waitcnt vmcnt(15)
    v_dot2_f32_bf16 v39, v108, v44, 0
    v_dot2_f32_bf16 v39, v109, v45, v39
    v_dot2_f32_bf16 v39, v110, v46, v39
    v_dot2_f32_bf16 v39, v111, v47, v39
    buffer_load_dwordx4 v[108:111], v26, s[4:7], s84 offen nt
    s_add_u32 s84, s84, s85
    s_waitcnt vmcnt(15)
    v_dot2_f32_bf16 v40, v112, v44, 0
    v_dot2_f32_bf16 v40, v113, v45, v40
    v_dot2_f32_bf16 v40, v114, v46, v40
    v_dot2_f32_bf16 v40, v115, v47, v40
    buffer_load_dwordx4 v[112:115], v26, s[4:7], s84 offen nt
    s_add_u32 s84, s84, s85
    s_waitcnt vmcnt(15)
    v_dot2_f32_bf16 v41, v116, v44, 0
    v_dot2_f32_bf16 v41, v117, v45, v41
    v_dot2_f32_bf16 v41, v118, v46, v41
    v_dot2_f32_bf16 v41, v119, v47, v41
    buffer_load_dwordx4 v[116:119], v26, s[4:7], s84 offen nt
    s_add_u32 s84, s84, s85
    s_waitcnt vmcnt(15)
    v_dot2_f32_bf16 v42, v120, v44, 0
    v_dot2_f32_bf16 v42, v121, v45, v42
    v_dot2_f32_bf16 v42, v122, v46, v42
    v_dot2_f32_bf16 v42, v123, v47, v42
    buffer_load_dwordx4 v[120:123], v26, s[4:7], s84 offen nt
    s_add_u32 s84, s84, s85
    s_waitcnt vmcnt(15)
    v_dot2_f32_bf16 v43, v124, v44, 0
    v_dot2_f32_bf16 v43, v125, v45, v43
    v_dot2_f32_bf16 v43, v126, v46, v43
    v_dot2_f32_bf16 v43, v127, v47, v43
    buffer_load_dwordx4 v[124:127], v26, s[4:7], s84 offen nt
    s_add_u32 s84, s84, s85
    v_add_u32 v27, 1, v27
    ds_write_b32 v56, v27 offset:4144
    v_add_f32_dpp v28, v28, v28 row_ror:8 row_mask:0xf bank_mask:0x3
    v_add_f32_dpp v29, v29, v29 row_ror:8 row_mask:0xf bank_mask:0x3
    v_add_f32_dpp v30, v30, v30 row_ror:8 row_mask:0xf bank_mask:0x3
    v_add_f32_dpp v31, v31, v31 row_ror:8 row_mask:0xf bank_mask:0x3
    v_add_f32_dpp v32, v32, v32 row_ror:8 row_mask:0xf bank_mask:0x3
    v_add_f32_dpp v33, v33, v33 row_ror:8 row_mask:0xf bank_mask:0x3
    v_add_f32_dpp v34, v34, v34 row_ror:8 row_mask:0xf bank_mask:0x3
    v_add_f32_dpp v35, v35, v35 row_ror:8 row_mask:0xf bank_mask:0x3
    v_add_f32_dpp v28, v36, v36 row_ror:8 row_mask:0xf bank_mask:0xc
    v_add_f32_dpp v29, v37, v37 row_ror:8 row_mask:0xf bank_mask:0xc
    v_add_f32_dpp v30, v38, v38 row_ror:8 row_mask:0xf bank_mask:0xc
    v_add_f32_dpp v31, v39, v39 row_ror:8 row_mask:0xf bank_mask:0xc
    v_add_f32_dpp v32, v40, v40 row_ror:8 row_mask:0xf bank_mask:0xc
    v_add_f32_dpp v33, v41, v41 row_ror:8 row_mask:0xf bank_mask:0xc
    v_add_f32_dpp v34, v42, v42 row_ror:8 row_mask:0xf bank_mask:0xc
    v_add_f32_dpp v35, v43, v43 row_ror:8 row_mask:0xf bank_mask:0xc
    v_add_f32_dpp v28, v28, v28 row_half_mirror row_mask:0xf bank_mask:0x5
    v_add_f32_dpp v29, v29, v29 row_half_mirror row_mask:0xf bank_mask:0x5
    v_add_f32_dpp v30, v30, v30 row_half_mirror row_mask:0xf bank_mask:0x5
    v_add_f32_dpp v31, v31, v31 row_half_mirror row_mask:0xf bank_mask:0x5
    v_add_f32_dpp v28, v32, v32 row_half_mirror row_mask:0xf bank_mask:0xa
    v_add_f32_dpp v29, v33, v33 row_half_mirror row_mask:0xf bank_mask:0xa
    v_add_f32_dpp v30, v34, v34 row_half_mirror row_mask:0xf bank_mask:0xa
    v_add_f32_dpp v31, v35, v35 row_half_mirror row_mask:0xf bank_mask:0xa
    v_add_f32_dpp v28, v28, v28 quad_perm:[2,3,0,1] row_mask:0xf bank_mask:0xf
    v_add_f32_dpp v29, v29, v29 quad_perm:[2,3,0,1] row_mask:0xf bank_mask:0xf
    v_add_f32_dpp v30, v30, v30 quad_perm:[2,3,0,1] row_mask:0xf bank_mask:0xf
    v_add_f32_dpp v31, v31, v31 quad_perm:[2,3,0,1] row_mask:0xf bank_mask:0xf
    v_mov_b32 v48, v49
    v_mov_b32 v49, v50
    v_mov_b32 v50, v51
    v_mov_b32 v51, v52
    v_cndmask_b32 v28, v28, v30, s[88:89]
    v_cndmask_b32 v29, v29, v31, s[88:89]
    v_mov_b32 v52, v53
    v_mov_b32 v53, v54
    v_mov_b32 v54, v55
    v_add_f32_dpp v28, v28, v28 quad_perm:[1,0,3,2] row_mask:0xf bank_mask:0xf
    v_add_f32_dpp v29, v29, v29 quad_perm:[1,0,3,2] row_mask:0xf bank_mask:0xf
    v_cndmask_b32 v55, v28, v29, s[90:91]
    s_add_u32 s86, s86, 1
    s_cmp_lt_u32 s86, 8
    s_cbranch_scc1 L_KLOOP
    v_cvt_pk_bf16_f32 v48, v48, v49
    v_cvt_pk_bf16_f32 v50, v50, v51
    v_cvt_pk_bf16_f32 v52, v52, v53
    v_cvt_pk_bf16_f32 v54, v54, v55
    v_and_b32 v49, s87, v48
    v_lshlrev_b32 v48, 16, v48
    v_and_b32 v51, s87, v50
    v_lshlrev_b32 v50, 16, v50
    v_and_b32 v53, s87, v52
    v_lshlrev_b32 v52, 16, v52
    v_and_b32 v55, s87, v54
    v_lshlrev_b32 v54, 16, v54
    v_mul_f32 v48, 0x3db504f3, v48
    v_mul_f32 v49, 0x3db504f3, v49
    v_mul_f32 v50, 0x3db504f3, v50
    v_mul_f32 v51, 0x3db504f3, v51
    v_mul_f32 v52, 0x3db504f3, v52
    v_mul_f32 v53, 0x3db504f3, v53
    v_mul_f32 v54, 0x3db504f3, v54
    v_mul_f32 v55, 0x3db504f3, v55
    v_cvt_pk_bf16_f32 v48, v48, v49
    v_cvt_pk_bf16_f32 v50, v50, v51
    v_cvt_pk_bf16_f32 v52, v52, v53
    v_cvt_pk_bf16_f32 v54, v54, v55
    v_and_b32 v49, s87, v48
    v_lshlrev_b32 v48, 16, v48
    v_and_b32 v51, s87, v50
    v_lshlrev_b32 v50, 16, v50
    v_and_b32 v53, s87, v52
    v_lshlrev_b32 v52, 16, v52
    v_and_b32 v55, s87, v54
    v_lshlrev_b32 v54, 16, v54
    v_max3_f32 v20, v48, v49, v50
    v_max3_f32 v21, v51, v52, v53
    v_max3_f32 v20, v20, v54, v55
    v_max_f32 v20, v20, v21
    s_nop 1
    v_max_f32_dpp v20, v20, v20 quad_perm:[1,0,3,2] row_mask:0xf bank_mask:0xf
    s_nop 1
    v_max_f32_dpp v20, v20, v20 quad_perm:[2,3,0,1] row_mask:0xf bank_mask:0xf
    s_nop 1
    v_max_f32_dpp v20, v20, v20 row_half_mirror row_mask:0xf bank_mask:0xf
    s_nop 1
    v_max_f32_dpp v20, v20, v20 row_mirror row_mask:0xf bank_mask:0xf
    v_mov_b32 v21, v20
    s_nop 1
    v_permlane16_swap_b32 v21, v20
    v_max_f32 v20, v20, v21
    v_mov_b32 v21, v20
    s_nop 1
    v_permlane32_swap_b32 v21, v20
    v_max_f32 v20, v20, v21
    v_sub_f32 v48, v48, v20
    v_sub_f32 v49, v49, v20
    v_sub_f32 v50, v50, v20
    v_sub_f32 v51, v51, v20
    v_sub_f32 v52, v52, v20
    v_sub_f32 v53, v53, v20
    v_sub_f32 v54, v54, v20
    v_sub_f32 v55, v55, v20
    v_mul_f32 v48, 0x3fb8aa3b, v48
    v_mul_f32 v49, 0x3fb8aa3b, v49
    v_mul_f32 v50, 0x3fb8aa3b, v50
    v_mul_f32 v51, 0x3fb8aa3b, v51
    v_mul_f32 v52, 0x3fb8aa3b, v52
    v_mul_f32 v53, 0x3fb8aa3b, v53
    v_mul_f32 v54, 0x3fb8aa3b, v54
    v_mul_f32 v55, 0x3fb8aa3b, v55
    v_exp_f32 v48, v48
    v_exp_f32 v49, v49
    v_exp_f32 v50, v50
    v_exp_f32 v51, v51
    v_exp_f32 v52, v52
    v_exp_f32 v53, v53
    v_exp_f32 v54, v54
    v_exp_f32 v55, v55
    ds_write_b32 v56, v20 offset:4096
    v_add_f32 v21, v48, v49
    v_add_f32 v23, v50, v51
    v_add_f32 v24, v52, v53
    v_add_f32 v25, v54, v55
    v_add_f32 v21, v21, v23
    v_add_f32 v24, v24, v25
    v_cvt_pk_bf16_f32 v48, v48, v48
    v_cvt_pk_bf16_f32 v49, v49, v49
    v_cvt_pk_bf16_f32 v50, v50, v50
    v_cvt_pk_bf16_f32 v51, v51, v51
    v_cvt_pk_bf16_f32 v52, v52, v52
    v_cvt_pk_bf16_f32 v53, v53, v53
    v_cvt_pk_bf16_f32 v54, v54, v54
    v_cvt_pk_bf16_f32 v55, v55, v55
    v_add_f32 v28, v21, v24
    v_mov_b32 v16, 0
    v_mov_b32 v17, 0
    v_mov_b32 v18, 0
    v_mov_b32 v19, 0
    s_mov_b32 s86, 0
    s_nop 0
L_VLOOP:
    v_and_b32_dpp v8, v48, v4 row_newbcast:0 row_mask:0xf bank_mask:0xf
    v_and_b32_dpp v9, v48, v5 row_newbcast:0 row_mask:0xf bank_mask:0xf
    v_and_b32_dpp v10, v48, v6 row_newbcast:0 row_mask:0xf bank_mask:0xf
    v_and_b32_dpp v11, v48, v7 row_newbcast:0 row_mask:0xf bank_mask:0xf
    v_and_b32_dpp v12, v48, v4 row_newbcast:1 row_mask:0xf bank_mask:0xf
    v_and_b32_dpp v13, v48, v5 row_newbcast:1 row_mask:0xf bank_mask:0xf
    v_and_b32_dpp v14, v48, v6 row_newbcast:1 row_mask:0xf bank_mask:0xf
    v_and_b32_dpp v15, v48, v7 row_newbcast:1 row_mask:0xf bank_mask:0xf
    s_waitcnt vmcnt(15)
    v_mfma_f32_16x16x32_bf16 v[16:19], v[8:11], v[64:67], v[16:19]
    buffer_load_dwordx4 v[64:67], v26, s[12:15], s84 offen nt
    s_add_u32 s84, s84, s85
    v_and_b32_dpp v8, v48, v4 row_newbcast:2 row_mask:0xf bank_mask:0xf
    v_and_b32_dpp v9, v48, v5 row_newbcast:2 row_mask:0xf bank_mask:0xf
    v_and_b32_dpp v10, v48, v6 row_newbcast:2 row_mask:0xf bank_mask:0xf
    v_and_b32_dpp v11, v48, v7 row_newbcast:2 row_mask:0xf bank_mask:0xf
    s_waitcnt vmcnt(15)
    v_mfma_f32_16x16x32_bf16 v[16:19], v[12:15], v[68:71], v[16:19]
    buffer_load_dwordx4 v[68:71], v26, s[12:15], s84 offen nt
    s_add_u32 s84, s84, s85
    v_and_b32_dpp v12, v48, v4 row_newbcast:3 row_mask:0xf bank_mask:0xf
    v_and_b32_dpp v13, v48, v5 row_newbcast:3 row_mask:0xf bank_mask:0xf
    v_and_b32_dpp v14, v48, v6 row_newbcast:3 row_mask:0xf bank_mask:0xf
    v_and_b32_dpp v15, v48, v7 row_newbcast:3 row_mask:0xf bank_mask:0xf
    s_waitcnt vmcnt(15)
    v_mfma_f32_16x16x32_bf16 v[16:19], v[8:11], v[72:75], v[16:19]
    buffer_load_dwordx4 v[72:75], v26, s[12:15], s84 offen nt
    s_add_u32 s84, s84, s85
    v_and_b32_dpp v8, v48, v4 row_newbcast:4 row_mask:0xf bank_mask:0xf
    v_and_b32_dpp v9, v48, v5 row_newbcast:4 row_mask:0xf bank_mask:0xf
    v_and_b32_dpp v10, v48, v6 row_newbcast:4 row_mask:0xf bank_mask:0xf
    v_and_b32_dpp v11, v48, v7 row_newbcast:4 row_mask:0xf bank_mask:0xf
    s_waitcnt vmcnt(15)
    v_mfma_f32_16x16x32_bf16 v[16:19], v[12:15], v[76:79], v[16:19]
    buffer_load_dwordx4 v[76:79], v26, s[12:15], s84 offen nt
    s_add_u32 s84, s84, s85
    v_and_b32_dpp v12, v48, v4 row_newbcast:5 row_mask:0xf bank_mask:0xf
    v_and_b32_dpp v13, v48, v5 row_newbcast:5 row_mask:0xf bank_mask:0xf
    v_and_b32_dpp v14, v48, v6 row_newbcast:5 row_mask:0xf bank_mask:0xf
    v_and_b32_dpp v15, v48, v7 row_newbcast:5 row_mask:0xf bank_mask:0xf
    s_waitcnt vmcnt(15)
    v_mfma_f32_16x16x32_bf16 v[16:19], v[8:11], v[80:83], v[16:19]
    buffer_load_dwordx4 v[80:83], v26, s[12:15], s84 offen nt
    s_add_u32 s84, s84, s85
    v_and_b32_dpp v8, v48, v4 row_newbcast:6 row_mask:0xf bank_mask:0xf
    v_and_b32_dpp v9, v48, v5 row_newbcast:6 row_mask:0xf bank_mask:0xf
    v_and_b32_dpp v10, v48, v6 row_newbcast:6 row_mask:0xf bank_mask:0xf
    v_and_b32_dpp v11, v48, v7 row_newbcast:6 row_mask:0xf bank_mask:0xf
    s_waitcnt vmcnt(15)
    v_mfma_f32_16x16x32_bf16 v[16:19], v[12:15], v[84:87], v[16:19]
    buffer_load_dwordx4 v[84:87], v26, s[12:15], s84 offen nt
    s_add_u32 s84, s84, s85
    v_and_b32_dpp v12, v48, v4 row_newbcast:7 row_mask:0xf bank_mask:0xf
    v_and_b32_dpp v13, v48, v5 row_newbcast:7 row_mask:0xf bank_mask:0xf
    v_and_b32_dpp v14, v48, v6 row_newbcast:7 row_mask:0xf bank_mask:0xf
    v_and_b32_dpp v15, v48, v7 row_newbcast:7 row_mask:0xf bank_mask:0xf
    s_waitcnt vmcnt(15)
    v_mfma_f32_16x16x32_bf16 v[16:19], v[8:11], v[88:91], v[16:19]
    buffer_load_dwordx4 v[88:91], v26, s[12:15], s84 offen nt
    s_add_u32 s84, s84, s85
    v_and_b32_dpp v8, v48, v4 row_newbcast:8 row_mask:0xf bank_mask:0xf
    v_and_b32_dpp v9, v48, v5 row_newbcast:8 row_mask:0xf bank_mask:0xf
    v_and_b32_dpp v10, v48, v6 row_newbcast:8 row_mask:0xf bank_mask:0xf
    v_and_b32_dpp v11, v48, v7 row_newbcast:8 row_mask:0xf bank_mask:0xf
    s_waitcnt vmcnt(15)
    v_mfma_f32_16x16x32_bf16 v[16:19], v[12:15], v[92:95], v[16:19]
    buffer_load_dwordx4 v[92:95], v26, s[12:15], s84 offen nt
    s_add_u32 s84, s84, s85
    v_and_b32_dpp v12, v48, v4 row_newbcast:9 row_mask:0xf bank_mask:0xf
    v_and_b32_dpp v13, v48, v5 row_newbcast:9 row_mask:0xf bank_mask:0xf
    v_and_b32_dpp v14, v48, v6 row_newbcast:9 row_mask:0xf bank_mask:0xf
    v_and_b32_dpp v15, v48, v7 row_newbcast:9 row_mask:0xf bank_mask:0xf
    s_waitcnt vmcnt(15)
    v_mfma_f32_16x16x32_bf16 v[16:19], v[8:11], v[96:99], v[16:19]
    buffer_load_dwordx4 v[96:99], v26, s[12:15], s84 offen nt
    s_add_u32 s84, s84, s85
    v_and_b32_dpp v8, v48, v4 row_newbcast:10 row_mask:0xf bank_mask:0xf
    v_and_b32_dpp v9, v48, v5 row_newbcast:10 row_mask:0xf bank_mask:0xf
    v_and_b32_dpp v10, v48, v6 row_newbcast:10 row_mask:0xf bank_mask:0xf
    v_and_b32_dpp v11, v48, v7 row_newbcast:10 row_mask:0xf bank_mask:0xf
    s_waitcnt vmcnt(15)
    v_mfma_f32_16x16x32_bf16 v[16:19], v[12:15], v[100:103], v[16:19]
    buffer_load_dwordx4 v[100:103], v26, s[12:15], s84 offen nt
    s_add_u32 s84, s84, s85
    v_and_b32_dpp v12, v48, v4 row_newbcast:11 row_mask:0xf bank_mask:0xf
    v_and_b32_dpp v13, v48, v5 row_newbcast:11 row_mask:0xf bank_mask:0xf
    v_and_b32_dpp v14, v48, v6 row_newbcast:11 row_mask:0xf bank_mask:0xf
    v_and_b32_dpp v15, v48, v7 row_newbcast:11 row_mask:0xf bank_mask:0xf
    s_waitcnt vmcnt(15)
    v_mfma_f32_16x16x32_bf16 v[16:19], v[8:11], v[104:107], v[16:19]
    buffer_load_dwordx4 v[104:107], v26, s[12:15], s84 offen nt
    s_add_u32 s84, s84, s85
    v_and_b32_dpp v8, v48, v4 row_newbcast:12 row_mask:0xf bank_mask:0xf
    v_and_b32_dpp v9, v48, v5 row_newbcast:12 row_mask:0xf bank_mask:0xf
    v_and_b32_dpp v10, v48, v6 row_newbcast:12 row_mask:0xf bank_mask:0xf
    v_and_b32_dpp v11, v48, v7 row_newbcast:12 row_mask:0xf bank_mask:0xf
    s_waitcnt vmcnt(15)
    v_mfma_f32_16x16x32_bf16 v[16:19], v[12:15], v[108:111], v[16:19]
    buffer_load_dwordx4 v[108:111], v26, s[12:15], s84 offen nt
    s_add_u32 s84, s84, s85
    v_and_b32_dpp v12, v48, v4 row_newbcast:13 row_mask:0xf bank_mask:0xf
    v_and_b32_dpp v13, v48, v5 row_newbcast:13 row_mask:0xf bank_mask:0xf
    v_and_b32_dpp v14, v48, v6 row_newbcast:13 row_mask:0xf bank_mask:0xf
    v_and_b32_dpp v15, v48, v7 row_newbcast:13 row_mask:0xf bank_mask:0xf
    s_waitcnt vmcnt(15)
    v_mfma_f32_16x16x32_bf16 v[16:19], v[8:11], v[112:115], v[16:19]
    buffer_load_dwordx4 v[112:115], v26, s[12:15], s84 offen nt
    s_add_u32 s84, s84, s85
    v_and_b32_dpp v8, v48, v4 row_newbcast:14 row_mask:0xf bank_mask:0xf
    v_and_b32_dpp v9, v48, v5 row_newbcast:14 row_mask:0xf bank_mask:0xf
    v_and_b32_dpp v10, v48, v6 row_newbcast:14 row_mask:0xf bank_mask:0xf
    v_and_b32_dpp v11, v48, v7 row_newbcast:14 row_mask:0xf bank_mask:0xf
    s_waitcnt vmcnt(15)
    v_mfma_f32_16x16x32_bf16 v[16:19], v[12:15], v[116:119], v[16:19]
    buffer_load_dwordx4 v[116:119], v26, s[12:15], s84 offen nt
    s_add_u32 s84, s84, s85
    v_and_b32_dpp v12, v48, v4 row_newbcast:15 row_mask:0xf bank_mask:0xf
    v_and_b32_dpp v13, v48, v5 row_newbcast:15 row_mask:0xf bank_mask:0xf
    v_and_b32_dpp v14, v48, v6 row_newbcast:15 row_mask:0xf bank_mask:0xf
    v_and_b32_dpp v15, v48, v7 row_newbcast:15 row_mask:0xf bank_mask:0xf
    s_waitcnt vmcnt(15)
    v_mfma_f32_16x16x32_bf16 v[16:19], v[8:11], v[120:123], v[16:19]
    buffer_load_dwordx4 v[120:123], v26, s[12:15], s84 offen nt
    s_add_u32 s84, s84, s85
    s_waitcnt vmcnt(15)
    v_mfma_f32_16x16x32_bf16 v[16:19], v[12:15], v[124:127], v[16:19]
    buffer_load_dwordx4 v[124:127], v26, s[12:15], s84 offen nt
    s_add_u32 s84, s84, s85
    v_add_u32 v27, 1, v27
    ds_write_b32 v56, v27 offset:4144
    v_mov_b32 v48, v49
    v_mov_b32 v49, v50
    v_mov_b32 v50, v51
    v_mov_b32 v51, v52
    v_mov_b32 v52, v53
    v_mov_b32 v53, v54
    v_mov_b32 v54, v55
    s_add_u32 s86, s86, 1
    s_cmp_eq_u32 s86, 1
    s_cbranch_scc0 L_NOL
    v_add_f32_dpp v28, v28, v28 quad_perm:[1,0,3,2] row_mask:0xf bank_mask:0xf
    s_nop 1
    v_add_f32_dpp v28, v28, v28 quad_perm:[2,3,0,1] row_mask:0xf bank_mask:0xf
    s_nop 1
    v_add_f32_dpp v28, v28, v28 row_half_mirror row_mask:0xf bank_mask:0xf
    s_nop 1
    v_add_f32_dpp v28, v28, v28 row_mirror row_mask:0xf bank_mask:0xf
    v_mov_b32 v21, v28
    s_nop 1
    v_permlane16_swap_b32 v21, v28
    v_add_f32 v28, v28, v21
    v_mov_b32 v21, v28
    s_nop 1
    v_permlane32_swap_b32 v21, v28
    v_add_f32 v28, v28, v21
    ds_write_b32 v56, v28 offset:4112
    v_bfe_u32 v20, v0, 6, 2
    v_lshl_add_u32 v21, v20, 5, v3
    v_and_b32 v23, 0xff, v0
    v_lshlrev_b32 v23, 4, v23
    s_nop 1
L_NOL:
    s_cmp_lt_u32 s86, 8
    s_cbranch_scc1 L_VLOOP
    s_mov_b32 exec_hi, 0
    ds_write_b128 v21, v[16:19] offset:4352
    s_mov_b32 exec_hi, -1
    s_waitcnt lgkmcnt(0)
    s_barrier
    s_barrier
    s_cmp_ge_u32 s76, 7
    s_cbranch_scc1 L_FIN
    v_cmp_gt_u32 vcc, 0x1a0, v0
    s_nop 1
    s_and_saveexec_b64 s[94:95], vcc
    ds_read_b128 v[28:31], v23 offset:6656
    ds_read_b128 v[32:35], v23 offset:9216
    ds_read_b128 v[36:39], v23 offset:11776
    ds_read_b128 v[40:43], v23 offset:14336
    s_waitcnt lgkmcnt(0)
    v_add_f32 v28, v28, v36
    v_add_f32 v29, v29, v37
    v_add_f32 v30, v30, v38
    v_add_f32 v31, v31, v39
    v_add_f32 v32, v32, v40
    v_add_f32 v33, v33, v41
    v_add_f32 v34, v34, v42
    v_add_f32 v35, v35, v43
    v_add_f32 v28, v28, v32
    v_add_f32 v29, v29, v33
    v_add_f32 v30, v30, v34
    v_add_f32 v31, v31, v35
    v_min_u32 v28, -2, v28
    v_min_u32 v29, -2, v29
    v_min_u32 v30, -2, v30
    v_min_u32 v31, -2, v31
    buffer_store_dwordx4 v[28:31], v2, s[44:47], 0 offen sc1
    s_mov_b64 exec, -1
    s_nop 0
L_FIN:
L_END:
    s_endpgm
.section .rodata,"a"
.p2align 6
.amdhsa_kernel parallel_sum__mha_block_cached__glu_gated_bilinear__decode_kernel
  .amdhsa_next_free_vgpr 256
  .amdhsa_next_free_sgpr 100
  .amdhsa_accum_offset 256
  .amdhsa_group_segment_fixed_size 0
  .amdhsa_kernarg_size 96
  .amdhsa_user_sgpr_count 2
  .amdhsa_user_sgpr_kernarg_segment_ptr 1
  .amdhsa_system_sgpr_workgroup_id_x 1
.end_amdhsa_kernel
```
